```python
import torch

def _softmax(x, axis=-1):
    return torch.softmax(x, dim=axis)
def _gelu(x):
    return torch.nn.functional.gelu(x, approximate="tanh")
def _silu(x):
    return torch.nn.functional.silu(x)
def _sigmoid(x):
    return torch.sigmoid(x)
def _layernorm(x, axis=-1, eps=1e-5):
    m = x.mean(dim=axis, keepdim=True)
    v = x.var(dim=axis, keepdim=True, unbiased=False)
    return (x - m) / torch.sqrt(v + eps)
def _scatter_add(tgt, idx, src, axis=0):
    return tgt.clone().index_add_(axis, idx, src)
def _segment_sum(src, seg, n):
    out = torch.zeros((n,) + src.shape[1:], dtype=src.dtype)
    return out.index_add_(0, seg, src)
def _pad(x, pw):
    flat = tuple(v for pair in reversed(pw) for v in pair)
    return torch.nn.functional.pad(x, flat)

kernel_name = 'interleave_layers__gqa_block_cached__glu_gated_reglu__decode'

def setup_inputs():

    _w = (lambda a: (lambda t: t.to(torch.bfloat16) if t.is_floating_point() else t)(torch.as_tensor(a)))
    def _A_setup():
        B, Sq, D = 2, 1, 512
        Hq, Hkv, Sk, Dh = 32, 8, 8192, 128
        assert Hq % Hkv == 0, (Hq, Hkv)
        return {
            "x": _w((lambda *s: torch.randn(*s, dtype=torch.bfloat16) * 0.05)(B, Sq, D)),
            "k_cache": _w((lambda *s: torch.randn(*s, dtype=torch.bfloat16) * 1.6)(B, Hkv, Sk, Dh)),
            "v_cache": _w((lambda *s: torch.randn(*s, dtype=torch.bfloat16) * 0.8)(B, Hkv, Sk, Dh)),
            "wq": _w((lambda *s: torch.randn(*s, dtype=torch.bfloat16) * 1.6)(D, Hq * Dh) * (D ** -0.5)),
            "wo": _w((lambda *s: torch.randn(*s, dtype=torch.bfloat16) * 0.8)(Hq * Dh, D) * ((Hq * Dh) ** -0.5)),
        }
    _A_in = _A_setup()

    def _B_setup():
        B, S, D, F = 2, 1, 512, 1792
        return {
            "x": _w((lambda *s: torch.randn(*s, dtype=torch.bfloat16) * 0.05)(B, S, D)),
            "W_gate": _w((lambda *s: torch.randn(*s, dtype=torch.bfloat16) * 0.4)(D, F) * (2.0 / D) ** 0.5),
            "W_up": _w((lambda *s: torch.randn(*s, dtype=torch.bfloat16) * 0.4)(D, F) * (2.0 / D) ** 0.5),
            "W_down": _w((lambda *s: torch.randn(*s, dtype=torch.bfloat16) * 0.4)(F, D) * (1.0 / F) ** 0.5),
        }
    _B_in = _B_setup()

    return {
        "A_x": _A_in["x"],
        "A_k_cache": _A_in["k_cache"],
        "A_v_cache": _A_in["v_cache"],
        "A_wq": _A_in["wq"],
        "A_wo": _A_in["wo"],
        "B_x": _B_in["x"],
        "B_W_gate": _B_in["W_gate"],
        "B_W_up": _B_in["W_up"],
        "B_W_down": _B_in["W_down"],
    }

def reference(A_x, A_k_cache, A_v_cache, A_wq, A_wo, B_x, B_W_gate, B_W_up, B_W_down):
    def _A_ref(x, k_cache, v_cache, wq, wo):
        B, Sq, D = x.shape
        Hq, Dh = 32, 128
        Hkv = k_cache.shape[1]
        rep = Hq // Hkv
        q = (lambda x, *d: x.permute(*d))((x @ wq).reshape(B, Sq, Hq, Dh), 0, 2, 1, 3)
        k = (lambda x, n, axis: torch.repeat_interleave(x, n, dim=axis))(k_cache, rep, axis=1)
        v = (lambda x, n, axis: torch.repeat_interleave(x, n, dim=axis))(v_cache, rep, axis=1)
        scores = torch.einsum("bhqd,bhkd->bhqk", q, k) * (Dh ** -0.5)
        p = _softmax(scores, axis=-1)
        o = torch.einsum("bhqk,bhkd->bhqd", p, v)
        return (lambda x, *d: x.permute(*d))(o, 0, 2, 1, 3).reshape(B, Sq, Hq * Dh) @ wo

    def _B_ref(x, W_gate, W_up, W_down):
        gate = torch.einsum("bsd,df->bsf", x, W_gate)
        up = torch.einsum("bsd,df->bsf", x, W_up)
        gate = gate * (lambda x, dt: x.to(dt))(gate > 0, gate.dtype)
        h = gate * up
        return torch.einsum("bsf,fd->bsd", h, W_down)

    x = A_x
    x = x + _A_ref(_layernorm(x, axis=-1), A_k_cache, A_v_cache, A_wq, A_wo)
    x = x + _B_ref(_layernorm(x, axis=-1), B_W_gate, B_W_up, B_W_down)
    x = x + _A_ref(_layernorm(x, axis=-1), A_k_cache, A_v_cache, A_wq, A_wo)
    x = x + _B_ref(_layernorm(x, axis=-1), B_W_gate, B_W_up, B_W_down)
    return x
```

```asm
; @launch grid=(256,1,1) block=(256,1,1) lds=66944
.amdgcn_target "amdgcn-amd-amdhsa--gfx950"
.text
.globl interleave_layers__gqa_block_cached__glu_gated_reglu__decode_kernel
.p2align 8
.type interleave_layers__gqa_block_cached__glu_gated_reglu__decode_kernel,@function
interleave_layers__gqa_block_cached__glu_gated_reglu__decode_kernel:
  s_cmp_ge_u32 s2, 256
  s_cbranch_scc1 L_end
  s_load_dwordx16 s[52:67], s[0:1], 0
  s_load_dwordx8 s[68:75], s[0:1], 64
  v_lshrrev_b32 v31, 6, v0
  v_and_b32 v30, 63, v0
  v_readfirstlane_b32 s3, v31
  s_mov_b32 s6, 0
  s_mov_b32 s76, 0x100000
  v_lshlrev_b32 v0, 4, v30
  v_and_b32 v4, 0x70, v0
  v_lshrrev_b32 v34, 3, v0
  v_and_b32 v34, 32, v34
  v_xor_b32 v33, v4, v34
  s_and_b32 s100, s3, 1
  s_lshl_b32 s100, s100, 6
  v_xor_b32 v33, s100, v33
  v_lshrrev_b32 v34, 7, v0
  v_lshl_add_u32 v33, v34, 13, v33
  s_bfe_u32 s97, s2, 0x20006
  s_lshl_b32 s97, s97, 20
  s_lshl_b32 s100, s3, 16
  s_add_u32 s97, s97, s100
  s_bfe_u32 s100, s2, 0x30000
  s_lshl_b32 s100, s100, 10
  s_add_u32 s97, s97, s100
  s_bfe_u32 s100, s2, 0x30003
  s_lshl_b32 s100, s100, 7
  s_add_u32 s97, s97, s100
  v_bfe_u32 v35, v30, 0, 1
  v_lshlrev_b32 v35, 10, v35
  v_bfe_u32 v31, v30, 4, 2
  v_lshl_add_u32 v35, v31, 4, v35
  v_bfe_u32 v34, v30, 0, 1
  v_lshlrev_b32 v34, 10, v34
  v_bfe_u32 v31, v30, 1, 3
  v_lshl_add_u32 v34, v31, 7, v34
  v_bfe_u32 v31, v30, 4, 2
  v_lshl_add_u32 v34, v31, 5, v34
  v_bfe_u32 v10, v30, 0, 3
  v_lshlrev_b32 v10, 3, v10
  v_bfe_u32 v31, v30, 5, 1
  v_lshl_add_u32 v10, v31, 2, v10
  s_bfe_u32 s95, s2, 0x20006
  s_lshl_b32 s95, s95, 8
  s_bfe_u32 s87, s3, 0x10001
  s_lshl_b32 s87, s87, 10
  s_bfe_u32 s100, s2, 0x30003
  s_lshl_b32 s100, s100, 7
  s_add_u32 s87, s87, s100
  s_bfe_u32 s100, s3, 0x10000
  s_lshl_b32 s100, s100, 6
  s_add_u32 s87, s87, s100
  v_bfe_u32 v32, v30, 0, 2
  v_lshlrev_b32 v32, 10, v32
  v_bfe_u32 v31, v30, 2, 1
  v_lshl_add_u32 v32, v31, 8, v32
  v_bfe_u32 v31, v30, 3, 1
  v_lshl_add_u32 v32, v31, 6, v32
  v_bfe_u32 v31, v30, 4, 2
  v_lshl_add_u32 v32, v31, 4, v32
  s_bfe_u32 s77, s2, 0x10007
  s_lshl_b32 s77, s77, 24
  s_bfe_u32 s100, s2, 0x30000
  s_lshl_b32 s100, s100, 21
  s_add_u32 s77, s77, s100
  s_bfe_u32 s100, s2, 0x40003
  s_lshl_b32 s100, s100, 17
  s_add_u32 s77, s77, s100
  s_lshl_b32 s100, s3, 13
  s_add_u32 s77, s77, s100
  s_waitcnt lgkmcnt(0)
  s_mov_b32 s20, s58
  s_and_b32 s21, s59, 0xffff
  s_mov_b32 s22, 0x400000
  s_mov_b32 s23, 0x20000
  s_lshl_b32 s100, s3, 10
  s_add_u32 m0, s100, 0
  s_nop 0
  buffer_load_dwordx4 v33, s[20:23], s97 offen nt lds
  s_lshl_b32 s100, s3, 10
  s_add_u32 m0, s100, 4096
  s_add_u32 s97, s97, 262144
  buffer_load_dwordx4 v33, s[20:23], s97 offen nt lds
  s_lshl_b32 s100, s3, 10
  s_add_u32 m0, s100, 8192
  s_add_u32 s97, s97, 262144
  buffer_load_dwordx4 v33, s[20:23], s97 offen nt lds
  s_lshl_b32 s100, s3, 10
  s_add_u32 m0, s100, 12288
  s_add_u32 s97, s97, 262144
  buffer_load_dwordx4 v33, s[20:23], s97 offen nt lds
  s_mov_b32 s40, s52
  s_and_b32 s41, s53, 0xffff
  s_mov_b32 s42, 0x800
  s_mov_b32 s43, 0x20000
  buffer_load_dwordx4 v[44:47], v35, s[40:43], s95 offen offset:0
  buffer_load_dwordx4 v[48:51], v35, s[40:43], s95 offen offset:64
  buffer_load_dwordx4 v[52:55], v35, s[40:43], s95 offen offset:128
  buffer_load_dwordx4 v[56:59], v35, s[40:43], s95 offen offset:192
  buffer_load_dwordx4 v[80:83], v34, s[40:43], 0 offen
  buffer_load_dwordx4 v[84:87], v34, s[40:43], 0 offen offset:16
  buffer_load_dword v22, v10, s[40:43], s87 offen
  v_mov_b32 v88, -1
  v_mov_b32 v89, -1
  v_mov_b32 v90, -1
  v_mov_b32 v91, -1
  s_bfe_u32 s97, s2, 0x40003
  s_lshl_b32 s97, s97, 17
  s_bfe_u32 s100, s2, 0x30000
  s_lshl_b32 s100, s100, 13
  s_add_u32 s97, s97, s100
  s_bfe_u32 s100, s2, 0x10007
  s_lshl_b32 s100, s100, 12
  s_add_u32 s97, s97, s100
  s_lshl_b32 s100, s3, 10
  s_add_u32 s97, s97, s100
  s_mov_b32 s16, s74
  s_and_b32 s17, s75, 0xffff
  s_mov_b32 s18, 0x200000
  s_mov_b32 s19, 0x20000
  buffer_store_dwordx4 v[88:91], v0, s[16:19], s97 offen sc1
  s_and_b32 s96, s2, 0xc4
  s_cmp_eq_u32 s96, 0xc4
  s_cbranch_scc0 L_rst
  s_add_u32 s97, s97, 0x10000
  buffer_store_dwordx4 v[88:91], v0, s[16:19], s97 offen sc1
L_rst:
  s_mov_b32 s8, s54
  s_and_b32 s9, s55, 0xffff
  s_mov_b32 s10, 0x2000000
  s_mov_b32 s11, 0x20000
  s_add_u32 s96, s77, 0
  buffer_load_dwordx4 v[128:131], v32, s[8:11], s96 offen offset:0 nt
  buffer_load_dwordx4 v[132:135], v32, s[8:11], s96 offen offset:512 nt
  buffer_load_dwordx4 v[136:139], v32, s[8:11], s96 offen offset:128 nt
  buffer_load_dwordx4 v[140:143], v32, s[8:11], s96 offen offset:640 nt
  s_add_u32 s96, s77, 4096
  buffer_load_dwordx4 v[144:147], v32, s[8:11], s96 offen offset:0 nt
  buffer_load_dwordx4 v[148:151], v32, s[8:11], s96 offen offset:512 nt
  buffer_load_dwordx4 v[152:155], v32, s[8:11], s96 offen offset:128 nt
  buffer_load_dwordx4 v[156:159], v32, s[8:11], s96 offen offset:640 nt
  s_mov_b32 s12, s56
  s_and_b32 s13, s57, 0xffff
  s_mov_b32 s14, 0x2000000
  s_mov_b32 s15, 0x20000
  s_mov_b32 s24, s60
  s_and_b32 s25, s61, 0xffff
  s_mov_b32 s26, 0x400000
  s_mov_b32 s27, 0x20000
  s_mov_b32 s28, s64
  s_and_b32 s29, s65, 0xffff
  s_mov_b32 s30, 0x1c0000
  s_mov_b32 s31, 0x20000
  s_mov_b32 s32, s66
  s_and_b32 s33, s67, 0xffff
  s_mov_b32 s34, 0x1c0000
  s_mov_b32 s35, 0x20000
  s_mov_b32 s36, s68
  s_and_b32 s37, s69, 0xffff
  s_mov_b32 s38, 0x1c0000
  s_mov_b32 s39, 0x20000
  s_mov_b32 s44, s70
  s_and_b32 s45, s71, 0xffff
  s_mov_b32 s46, 0x800
  s_mov_b32 s47, 0x20000
  s_mov_b32 s48, s72
  s_and_b32 s49, s73, 0xffff
  s_mov_b32 s50, 0x100
  s_mov_b32 s51, 0x20000
  v_lshlrev_b32 v1, 2, v30
  v_bfe_u32 v5, v30, 0, 4
  v_lshlrev_b32 v5, 4, v5
  v_bfe_u32 v6, v30, 4, 2
  v_lshlrev_b32 v6, 4, v6
  v_bfe_u32 v3, v30, 0, 4
  v_lshlrev_b32 v3, 6, v3
  v_bfe_u32 v31, v30, 4, 2
  v_lshl_add_u32 v3, v31, 4, v3
  v_bfe_u32 v2, v30, 4, 2
  v_lshlrev_b32 v2, 10, v2
  v_bfe_u32 v31, v30, 0, 4
  v_lshl_add_u32 v2, v31, 2, v2
  v_bfe_u32 v7, v30, 0, 1
  v_lshlrev_b32 v7, 17, v7
  v_bfe_u32 v31, v30, 4, 2
  v_lshl_add_u32 v7, v31, 3, v7
  v_bfe_u32 v8, v30, 0, 1
  v_lshlrev_b32 v8, 19, v8
  v_bfe_u32 v31, v30, 4, 2
  v_lshl_add_u32 v8, v31, 4, v8
  v_bfe_u32 v9, v30, 4, 2
  v_lshlrev_b32 v9, 11, v9
  v_bfe_u32 v31, v30, 0, 4
  v_lshl_add_u32 v9, v31, 4, v9
  v_bfe_u32 v19, v30, 0, 4
  v_lshlrev_b32 v19, 4, v19
  v_bfe_u32 v31, v30, 5, 1
  v_lshl_add_u32 v19, v31, 3, v19
  v_bfe_u32 v16, v30, 0, 1
  v_lshlrev_b32 v16, 7, v16
  v_bfe_u32 v31, v30, 4, 2
  v_lshl_add_u32 v16, v31, 4, v16
  v_add_u32 v16, 65664, v16
  v_and_b32 v18, 32, v0
  v_lshl_add_u32 v18, v18, 3, v16
  v_bfe_u32 v17, v30, 4, 2
  v_lshlrev_b32 v17, 10, v17
  v_bfe_u32 v31, v30, 2, 2
  v_lshl_add_u32 v17, v31, 7, v17
  v_bfe_u32 v31, v30, 0, 2
  v_lshl_add_u32 v17, v31, 3, v17
  v_bfe_u32 v31, v30, 3, 2
  v_xor_b32 v31, s3, v31
  v_lshl_add_u32 v17, v31, 5, v17
  s_lshl_b32 s96, s3, 5
  s_add_u32 s96, s96, 0x10080
  v_bfe_u32 v15, v30, 5, 1
  v_lshlrev_b32 v15, 7, v15
  v_bfe_u32 v31, v30, 0, 4
  v_lshl_add_u32 v15, v31, 1, v15
  v_add_u32 v15, s96, v15
  v_bfe_u32 v11, v30, 4, 1
  v_lshlrev_b32 v11, 1, v11
  v_bfe_u32 v31, v30, 3, 1
  v_lshl_add_u32 v11, v31, 0, v11
  v_xor_b32 v11, v11, v30
  v_lshlrev_b32 v11, 4, v11
  s_lshl_b32 s96, s3, 11
  s_add_u32 s96, s96, 0xe000
  v_add_u32 v11, s96, v11
  v_bfe_u32 v12, v30, 4, 1
  v_lshlrev_b32 v12, 1, v12
  v_bfe_u32 v31, v30, 1, 1
  v_lshl_add_u32 v12, v31, 0, v12
  v_xor_b32 v12, s3, v12
  v_lshlrev_b32 v12, 4, v12
  v_bfe_u32 v36, v30, 4, 2
  v_lshlrev_b32 v36, 8, v36
  v_bfe_u32 v31, v30, 0, 2
  v_lshl_add_u32 v36, v31, 6, v36
  v_bfe_u32 v31, v30, 2, 2
  v_lshl_add_u32 v36, v31, 2, v36
  v_add_u32 v36, 57344, v36
  v_add_u32 v12, v12, v36
  s_lshl_b32 s96, s3, 3
  s_add_u32 s96, s96, 0x10000
  v_bfe_u32 v13, v30, 0, 2
  v_lshlrev_b32 v13, 5, v13
  v_add_u32 v13, s96, v13
  s_lshl_b32 s96, s3, 5
  s_add_u32 s96, s96, 0x10000
  v_mov_b32 v14, s96
  s_lshl_b32 s96, s3, 6
  s_add_u32 s96, s96, 0x10180
  v_add_u32 v20, s96, v10
  v_mov_b32 v31, 0x3f803f80
  v_accvgpr_write_b32 a200, v31
  v_accvgpr_write_b32 a201, v31
  v_accvgpr_write_b32 a202, v31
  v_accvgpr_write_b32 a203, v31
  v_add_u32 v36, 66176, v1
  ds_write_b32 v36, v31
  v_accvgpr_write_b32 a192, 0
  v_accvgpr_write_b32 a193, 0
  v_accvgpr_write_b32 a194, 0
  v_accvgpr_write_b32 a195, 0
  v_accvgpr_write_b32 a196, 0
  v_accvgpr_write_b32 a197, 0
  v_accvgpr_write_b32 a198, 0
  v_accvgpr_write_b32 a199, 0
  s_bfe_u32 s4, s2, 0x30000
  s_lshl_b32 s4, s4, 18
  s_bfe_u32 s5, s2, 0x20006
  s_lshl_b32 s5, s5, 3
  s_bfe_u32 s100, s2, 0x30000
  s_add_u32 s5, s5, s100
  s_bfe_u32 s80, s2, 0x10007
  s_lshl_b32 s80, s80, 14
  s_lshl_b32 s100, s3, 12
  s_add_u32 s80, s80, s100
  s_bfe_u32 s100, s2, 0x40003
  s_lshl_b32 s100, s100, 6
  s_add_u32 s80, s80, s100
  s_add_u32 s80, s80, s4
  s_bfe_u32 s81, s2, 0x10007
  s_lshl_b32 s81, s81, 8
  s_lshl_b32 s100, s3, 6
  s_add_u32 s81, s81, s100
  s_bfe_u32 s100, s2, 0x40003
  s_lshl_b32 s100, s100, 2
  s_add_u32 s81, s81, s100
  s_add_u32 s81, s81, s4
  s_add_u32 s81, s81, 0xbe00
  s_bfe_u32 s82, s3, 0x10000
  s_lshl_b32 s82, s82, 14
  s_bfe_u32 s100, s2, 0x20006
  s_lshl_b32 s100, s100, 12
  s_add_u32 s82, s82, s100
  s_add_u32 s82, s82, s4
  s_bfe_u32 s83, s3, 0x10000
  s_lshl_b32 s83, s83, 8
  s_bfe_u32 s100, s2, 0x20006
  s_lshl_b32 s100, s100, 6
  s_add_u32 s83, s83, s100
  s_add_u32 s83, s83, s4
  s_add_u32 s83, s83, 0xbe00
  s_bfe_u32 s84, s3, 0x10000
  s_lshl_b32 s84, s84, 19
  s_bfe_u32 s100, s2, 0x20004
  s_lshl_b32 s100, s100, 17
  s_add_u32 s84, s84, s100
  s_bfe_u32 s100, s2, 0x10003
  s_lshl_b32 s100, s100, 13
  s_add_u32 s84, s84, s100
  s_bfe_u32 s100, s3, 0x10001
  s_lshl_b32 s100, s100, 12
  s_add_u32 s84, s84, s100
  s_bfe_u32 s100, s2, 0x30000
  s_lshl_b32 s100, s100, 9
  s_add_u32 s84, s84, s100
  s_bfe_u32 s100, s2, 0x20006
  s_lshl_b32 s100, s100, 7
  s_add_u32 s84, s84, s100
  s_add_u32 s84, s84, 0xc000
  s_bfe_u32 s93, s2, 0x20004
  s_lshl_b32 s93, s93, 17
  s_bfe_u32 s100, s2, 0x10003
  s_lshl_b32 s100, s100, 13
  s_add_u32 s93, s93, s100
  s_bfe_u32 s100, s3, 0x10001
  s_lshl_b32 s100, s100, 12
  s_add_u32 s93, s93, s100
  s_bfe_u32 s100, s2, 0x20006
  s_lshl_b32 s100, s100, 10
  s_add_u32 s93, s93, s100
  s_bfe_u32 s100, s2, 0x30000
  s_lshl_b32 s100, s100, 7
  s_add_u32 s93, s93, s100
  s_bfe_u32 s100, s3, 0x10000
  s_lshl_b32 s100, s100, 6
  s_add_u32 s93, s93, s100
  s_add_u32 s93, s93, 0x10c000
  s_bfe_u32 s85, s3, 0x10001
  s_lshl_b32 s85, s85, 19
  s_bfe_u32 s100, s2, 0x20004
  s_lshl_b32 s100, s100, 17
  s_add_u32 s85, s85, s100
  s_bfe_u32 s100, s2, 0x10003
  s_lshl_b32 s100, s100, 13
  s_add_u32 s85, s85, s100
  s_bfe_u32 s100, s3, 0x10000
  s_lshl_b32 s100, s100, 12
  s_add_u32 s85, s85, s100
  s_add_u32 s85, s85, 0xc000
  s_add_u32 s86, s85, 0x100000
  s_bfe_u32 s88, s2, 0x20006
  s_lshl_b32 s88, s88, 8
  s_bfe_u32 s100, s2, 0x30003
  s_lshl_b32 s100, s100, 5
  s_add_u32 s88, s88, s100
  s_bfe_u32 s100, s3, 0x10000
  s_lshl_b32 s100, s100, 4
  s_add_u32 s88, s88, s100
  s_bfe_u32 s100, s3, 0x10001
  s_lshl_b32 s100, s100, 3
  s_add_u32 s88, s88, s100
  s_add_u32 s88, s88, s4
  s_add_u32 s88, s88, 0xb000
  s_bfe_u32 s89, s2, 0x10007
  s_lshl_b32 s89, s89, 3
  s_add_u32 s89, s89, s4
  s_add_u32 s89, s89, 0xbc00
  s_bfe_u32 s91, s2, 0x20006
  s_lshl_b32 s91, s91, 13
  s_bfe_u32 s100, s2, 0x30003
  s_lshl_b32 s100, s100, 10
  s_add_u32 s91, s91, s100
  s_lshl_b32 s100, s3, 8
  s_add_u32 s91, s91, s100
  s_add_u32 s91, s91, s4
  s_add_u32 s91, s91, 0x20000
  s_bfe_u32 s94, s2, 0x10006
  s_lshl_b32 s94, s94, 12
  s_bfe_u32 s100, s2, 0x10007
  s_lshl_b32 s100, s100, 17
  s_add_u32 s94, s94, s100
  s_bfe_u32 s100, s2, 0x30003
  s_lshl_b32 s100, s100, 9
  s_add_u32 s94, s94, s100
  s_lshl_b32 s100, s3, 7
  s_add_u32 s94, s94, s100
  s_add_u32 s94, s94, s4
  s_add_u32 s94, s94, 0x8000
  s_bfe_u32 s96, s2, 0x20006
  s_cmp_lt_u32 s5, 28
  s_cselect_b32 s96, s96, 0
  s_lshl_b32 s90, s96, 8
  s_lshl_b32 s96, s96, 13
  s_lshl_b32 s92, s3, 8
  s_add_u32 s92, s92, s4
  s_add_u32 s92, s92, 0x20000
  s_add_u32 s92, s92, s96
  s_add_u32 s90, s90, s4
  s_add_u32 s90, s90, 0xb000
  s_bfe_u32 s79, s2, 0x20006
  s_lshl_b32 s79, s79, 8
  s_bfe_u32 s100, s2, 0x20004
  s_lshl_b32 s100, s100, 6
  s_add_u32 s79, s79, s100
  s_bfe_u32 s100, s2, 0x10003
  s_lshl_b32 s100, s100, 11
  s_add_u32 s79, s79, s100
  s_bfe_u32 s100, s3, 0x10001
  s_lshl_b32 s100, s100, 10
  s_add_u32 s79, s79, s100
  s_bfe_u32 s100, s3, 0x10000
  s_lshl_b32 s100, s100, 5
  s_add_u32 s79, s79, s100
  s_add_u32 s79, s79, s4
  s_add_u32 s79, s79, 0xa000
  s_bfe_u32 s78, s2, 0x10007
  s_lshl_b32 s78, s78, 17
  s_add_u32 s78, s78, s4
  s_add_u32 s78, s78, 0xa000
  s_mov_b32 s98, 0x05040100
  s_mov_b32 s99, 0x07060302
  s_waitcnt vmcnt(8)
  s_add_u32 s96, s77, 32768
  buffer_load_dwordx4 v[160:163], v32, s[8:11], s96 offen offset:0 nt
  buffer_load_dwordx4 v[164:167], v32, s[8:11], s96 offen offset:512 nt
  v_mov_b32 v90, 0
  v_mov_b32 v91, 0
  v_lshlrev_b32 v36, 16, v80
  v_and_b32 v37, 0xffff0000, v80
  v_add_f32 v90, v90, v36
  v_fmac_f32 v91, v36, v36
  v_add_f32 v90, v90, v37
  v_fmac_f32 v91, v37, v37
  v_lshlrev_b32 v36, 16, v81
  v_and_b32 v37, 0xffff0000, v81
  v_add_f32 v90, v90, v36
  v_fmac_f32 v91, v36, v36
  v_add_f32 v90, v90, v37
  v_fmac_f32 v91, v37, v37
  v_lshlrev_b32 v36, 16, v82
  v_and_b32 v37, 0xffff0000, v82
  v_add_f32 v90, v90, v36
  v_fmac_f32 v91, v36, v36
  v_add_f32 v90, v90, v37
  v_fmac_f32 v91, v37, v37
  v_lshlrev_b32 v36, 16, v83
  v_and_b32 v37, 0xffff0000, v83
  v_add_f32 v90, v90, v36
  v_fmac_f32 v91, v36, v36
  v_add_f32 v90, v90, v37
  v_fmac_f32 v91, v37, v37
  v_lshlrev_b32 v36, 16, v84
  v_and_b32 v37, 0xffff0000, v84
  v_add_f32 v90, v90, v36
  v_fmac_f32 v91, v36, v36
  v_add_f32 v90, v90, v37
  v_fmac_f32 v91, v37, v37
  v_lshlrev_b32 v36, 16, v85
  v_and_b32 v37, 0xffff0000, v85
  v_add_f32 v90, v90, v36
  v_fmac_f32 v91, v36, v36
  v_add_f32 v90, v90, v37
  v_fmac_f32 v91, v37, v37
  v_lshlrev_b32 v36, 16, v86
  v_and_b32 v37, 0xffff0000, v86
  v_add_f32 v90, v90, v36
  v_fmac_f32 v91, v36, v36
  v_add_f32 v90, v90, v37
  v_fmac_f32 v91, v37, v37
  v_lshlrev_b32 v36, 16, v87
  v_and_b32 v37, 0xffff0000, v87
  v_add_f32 v90, v90, v36
  v_fmac_f32 v91, v36, v36
  v_add_f32 v90, v90, v37
  v_fmac_f32 v91, v37, v37
  v_lshlrev_b32 v21, 16, v22
  v_and_b32 v22, 0xffff0000, v22
  buffer_load_dwordx4 v[168:171], v32, s[8:11], s96 offen offset:128 nt
  buffer_load_dwordx4 v[172:175], v32, s[8:11], s96 offen offset:640 nt
  s_barrier
  ds_read_b64_tr_b16 a[128:129], v17 offset:0
  ds_read_b64_tr_b16 a[130:131], v17 offset:512
  ds_read_b64_tr_b16 a[132:133], v17 offset:4096
  ds_read_b64_tr_b16 a[134:135], v17 offset:4608
  ds_read_b64_tr_b16 a[136:137], v17 offset:8192
  ds_read_b64_tr_b16 a[138:139], v17 offset:8704
  ds_read_b64_tr_b16 a[140:141], v17 offset:12288
  ds_read_b64_tr_b16 a[142:143], v17 offset:12800
  v_add_f32_dpp v90, v90, v90 row_ror:2 row_mask:0xf bank_mask:0xf
  v_add_f32_dpp v91, v91, v91 row_ror:2 row_mask:0xf bank_mask:0xf
  s_nop 0
  v_add_f32_dpp v90, v90, v90 row_ror:4 row_mask:0xf bank_mask:0xf
  v_add_f32_dpp v91, v91, v91 row_ror:4 row_mask:0xf bank_mask:0xf
  s_nop 0
  v_add_f32_dpp v90, v90, v90 row_ror:8 row_mask:0xf bank_mask:0xf
  v_add_f32_dpp v91, v91, v91 row_ror:8 row_mask:0xf bank_mask:0xf
  v_mov_b32 v36, v90
  v_mov_b32 v37, v91
  s_nop 0
  v_permlane16_swap_b32 v90, v36
  v_permlane16_swap_b32 v91, v37
  v_add_f32 v90, v90, v36
  v_add_f32 v91, v91, v37
  v_mov_b32 v36, v90
  v_mov_b32 v37, v91
  s_nop 0
  v_permlane32_swap_b32 v90, v36
  v_permlane32_swap_b32 v91, v37
  v_add_f32 v90, v90, v36
  v_add_f32 v91, v91, v37
  v_mul_f32 v90, 0xbb000000, v90
  v_mul_f32 v91, 0x3b000000, v91
  v_fma_f32 v91, -v90, v90, v91
  v_max_f32 v91, 0, v91
  v_add_f32 v91, 0x3727c5ac, v91
  v_rsq_f32 v91, v91
  s_nop 0
  v_mul_f32 v91, 0x3e0293ee, v91
  v_mul_f32 v90, v90, v91
  s_waitcnt lgkmcnt(0)
  s_getreg_b32 s96, hwreg(HW_REG_XCC_ID)
  s_and_b32 s96, s96, 7
  s_mul_i32 s7, s96, 6
  s_cmp_eq_u32 s3, 0
  s_cbranch_scc0 L_noarr_1
  s_and_b32 s96, s2, 7
  s_lshl_b32 s96, s96, 5
  s_lshl_b64 s[100:101], 1, s7
  s_add_u32 s101, s101, 0x10000
  s_atomic_add_x2 s[100:101], s[48:49], s96
L_noarr_1:
  v_mfma_f32_16x16x32_bf16 v[24:27], a[128:131], a[200:203], 0
  v_mfma_f32_16x16x32_bf16 v[24:27], a[132:135], a[200:203], v[24:27]
  v_mfma_f32_16x16x32_bf16 v[24:27], a[136:139], a[200:203], v[24:27]
  v_mfma_f32_16x16x32_bf16 v[24:27], a[140:143], a[200:203], v[24:27]
  v_mfma_f32_16x16x32_bf16 v[60:63], a[128:131], v[44:47], 0
  v_mfma_f32_16x16x32_bf16 v[60:63], a[132:135], v[48:51], v[60:63]
  v_mfma_f32_16x16x32_bf16 v[60:63], a[136:139], v[52:55], v[60:63]
  v_mfma_f32_16x16x32_bf16 v[60:63], a[140:143], v[56:59], v[60:63]
  s_nop 3
  v_mul_f32 v64, v90, v24
  v_mul_f32 v65, v90, v25
  v_mul_f32 v66, v90, v26
  v_mul_f32 v67, v90, v27
  v_fmac_f32 v64, v91, v60
  v_fmac_f32 v65, v91, v61
  v_fmac_f32 v66, v91, v62
  v_fmac_f32 v67, v91, v63
  v_cvt_pk_bf16_f32 v60, v64, v65
  v_cvt_pk_bf16_f32 v61, v66, v67
  v_cvt_pk_bf16_f32 v24, v24, v25
  v_cvt_pk_bf16_f32 v25, v26, v27
  v_bfe_u32 v36, v30, 0, 3
  v_lshlrev_b32 v36, 5, v36
  s_add_u32 s96, s77, 36864
  buffer_load_dwordx4 v[176:179], v32, s[8:11], s96 offen offset:0 nt
  buffer_load_dwordx4 v[180:183], v32, s[8:11], s96 offen offset:512 nt
  buffer_load_dwordx4 v[184:187], v32, s[8:11], s96 offen offset:128 nt
  buffer_load_dwordx4 v[188:191], v32, s[8:11], s96 offen offset:640 nt
  s_waitcnt vmcnt(8)
  s_add_u32 s96, s77, 65536
  buffer_load_dwordx4 v[192:195], v32, s[8:11], s96 offen offset:0 nt
  v_mov_b32 v96, v128
  v_mov_b32 v97, v129
  v_mov_b32 v98, v130
  v_mov_b32 v99, v131
  v_mov_b32_dpp v96, v132 row_ror:8 row_mask:0xf bank_mask:0xc
  v_mov_b32_dpp v97, v133 row_ror:8 row_mask:0xf bank_mask:0xc
  v_mov_b32_dpp v98, v134 row_ror:8 row_mask:0xf bank_mask:0xc
  v_mov_b32_dpp v99, v135 row_ror:8 row_mask:0xf bank_mask:0xc
  v_mov_b32_dpp v132, v128 row_ror:8 row_mask:0xf bank_mask:0x3
  v_mov_b32_dpp v133, v129 row_ror:8 row_mask:0xf bank_mask:0x3
  buffer_load_dwordx4 v[196:199], v32, s[8:11], s96 offen offset:512 nt
  v_mov_b32_dpp v134, v130 row_ror:8 row_mask:0xf bank_mask:0x3
  v_mov_b32_dpp v135, v131 row_ror:8 row_mask:0xf bank_mask:0x3
  v_accvgpr_write_b32 a0, v96
  v_accvgpr_write_b32 a1, v97
  v_accvgpr_write_b32 a2, v98
  v_accvgpr_write_b32 a3, v99
  v_accvgpr_write_b32 a4, v132
  v_accvgpr_write_b32 a5, v133
  v_accvgpr_write_b32 a6, v134
  v_accvgpr_write_b32 a7, v135
  buffer_load_dwordx4 v[200:203], v32, s[8:11], s96 offen offset:128 nt
  v_mov_b32 v96, v136
  v_mov_b32 v97, v137
  v_mov_b32 v98, v138
  v_mov_b32 v99, v139
  v_mov_b32_dpp v96, v140 row_ror:8 row_mask:0xf bank_mask:0xc
  v_mov_b32_dpp v97, v141 row_ror:8 row_mask:0xf bank_mask:0xc
  v_mov_b32_dpp v98, v142 row_ror:8 row_mask:0xf bank_mask:0xc
  v_mov_b32_dpp v99, v143 row_ror:8 row_mask:0xf bank_mask:0xc
  v_mov_b32_dpp v140, v136 row_ror:8 row_mask:0xf bank_mask:0x3
  v_mov_b32_dpp v141, v137 row_ror:8 row_mask:0xf bank_mask:0x3
  buffer_load_dwordx4 v[204:207], v32, s[8:11], s96 offen offset:640 nt
  v_mov_b32_dpp v142, v138 row_ror:8 row_mask:0xf bank_mask:0x3
  v_mov_b32_dpp v143, v139 row_ror:8 row_mask:0xf bank_mask:0x3
  v_accvgpr_write_b32 a8, v96
  v_accvgpr_write_b32 a9, v97
  v_accvgpr_write_b32 a10, v98
  v_accvgpr_write_b32 a11, v99
  v_accvgpr_write_b32 a12, v140
  v_accvgpr_write_b32 a13, v141
  v_accvgpr_write_b32 a14, v142
  v_accvgpr_write_b32 a15, v143
  s_add_u32 s96, s77, 69632
  buffer_load_dwordx4 v[208:211], v32, s[8:11], s96 offen offset:0 nt
  v_mov_b32 v96, v144
  v_mov_b32 v97, v145
  v_mov_b32 v98, v146
  v_mov_b32 v99, v147
  v_mov_b32_dpp v96, v148 row_ror:8 row_mask:0xf bank_mask:0xc
  v_mov_b32_dpp v97, v149 row_ror:8 row_mask:0xf bank_mask:0xc
  v_mov_b32_dpp v98, v150 row_ror:8 row_mask:0xf bank_mask:0xc
  v_mov_b32_dpp v99, v151 row_ror:8 row_mask:0xf bank_mask:0xc
  v_mov_b32_dpp v148, v144 row_ror:8 row_mask:0xf bank_mask:0x3
  v_mov_b32_dpp v149, v145 row_ror:8 row_mask:0xf bank_mask:0x3
  buffer_load_dwordx4 v[212:215], v32, s[8:11], s96 offen offset:512 nt
  v_mov_b32_dpp v150, v146 row_ror:8 row_mask:0xf bank_mask:0x3
  v_mov_b32_dpp v151, v147 row_ror:8 row_mask:0xf bank_mask:0x3
  v_accvgpr_write_b32 a64, v96
  v_accvgpr_write_b32 a65, v97
  v_accvgpr_write_b32 a66, v98
  v_accvgpr_write_b32 a67, v99
  v_accvgpr_write_b32 a68, v148
  v_accvgpr_write_b32 a69, v149
  v_accvgpr_write_b32 a70, v150
  v_accvgpr_write_b32 a71, v151
  buffer_load_dwordx4 v[216:219], v32, s[8:11], s96 offen offset:128 nt
  v_mov_b32 v96, v152
  v_mov_b32 v97, v153
  v_mov_b32 v98, v154
  v_mov_b32 v99, v155
  v_mov_b32_dpp v96, v156 row_ror:8 row_mask:0xf bank_mask:0xc
  v_mov_b32_dpp v97, v157 row_ror:8 row_mask:0xf bank_mask:0xc
  v_mov_b32_dpp v98, v158 row_ror:8 row_mask:0xf bank_mask:0xc
  v_mov_b32_dpp v99, v159 row_ror:8 row_mask:0xf bank_mask:0xc
  v_mov_b32_dpp v156, v152 row_ror:8 row_mask:0xf bank_mask:0x3
  v_mov_b32_dpp v157, v153 row_ror:8 row_mask:0xf bank_mask:0x3
  buffer_load_dwordx4 v[220:223], v32, s[8:11], s96 offen offset:640 nt
  v_mov_b32_dpp v158, v154 row_ror:8 row_mask:0xf bank_mask:0x3
  v_mov_b32_dpp v159, v155 row_ror:8 row_mask:0xf bank_mask:0x3
  v_accvgpr_write_b32 a72, v96
  v_accvgpr_write_b32 a73, v97
  v_accvgpr_write_b32 a74, v98
  v_accvgpr_write_b32 a75, v99
  v_accvgpr_write_b32 a76, v156
  v_accvgpr_write_b32 a77, v157
  v_accvgpr_write_b32 a78, v158
  v_accvgpr_write_b32 a79, v159
  s_waitcnt vmcnt(8)
  s_add_u32 s96, s77, 98304
  buffer_load_dwordx4 v[224:227], v32, s[8:11], s96 offen offset:0 nt
  v_mov_b32 v96, v160
  v_mov_b32 v97, v161
  v_mov_b32 v98, v162
  v_mov_b32 v99, v163
  v_mov_b32_dpp v96, v164 row_ror:8 row_mask:0xf bank_mask:0xc
  v_mov_b32_dpp v97, v165 row_ror:8 row_mask:0xf bank_mask:0xc
  v_mov_b32_dpp v98, v166 row_ror:8 row_mask:0xf bank_mask:0xc
  v_mov_b32_dpp v99, v167 row_ror:8 row_mask:0xf bank_mask:0xc
  v_mov_b32_dpp v164, v160 row_ror:8 row_mask:0xf bank_mask:0x3
  v_mov_b32_dpp v165, v161 row_ror:8 row_mask:0xf bank_mask:0x3
  buffer_load_dwordx4 v[228:231], v32, s[8:11], s96 offen offset:512 nt
  v_mov_b32_dpp v166, v162 row_ror:8 row_mask:0xf bank_mask:0x3
  v_mov_b32_dpp v167, v163 row_ror:8 row_mask:0xf bank_mask:0x3
  v_accvgpr_write_b32 a16, v96
  v_accvgpr_write_b32 a17, v97
  v_accvgpr_write_b32 a18, v98
  v_accvgpr_write_b32 a19, v99
  v_accvgpr_write_b32 a20, v164
  v_accvgpr_write_b32 a21, v165
  v_accvgpr_write_b32 a22, v166
  v_accvgpr_write_b32 a23, v167
  buffer_load_dwordx4 v[232:235], v32, s[8:11], s96 offen offset:128 nt
  v_mov_b32 v96, v168
  v_mov_b32 v97, v169
  v_mov_b32 v98, v170
  v_mov_b32 v99, v171
  v_mov_b32_dpp v96, v172 row_ror:8 row_mask:0xf bank_mask:0xc
  v_mov_b32_dpp v97, v173 row_ror:8 row_mask:0xf bank_mask:0xc
  v_mov_b32_dpp v98, v174 row_ror:8 row_mask:0xf bank_mask:0xc
  v_mov_b32_dpp v99, v175 row_ror:8 row_mask:0xf bank_mask:0xc
  v_mov_b32_dpp v172, v168 row_ror:8 row_mask:0xf bank_mask:0x3
  v_mov_b32_dpp v173, v169 row_ror:8 row_mask:0xf bank_mask:0x3
  buffer_load_dwordx4 v[236:239], v32, s[8:11], s96 offen offset:640 nt
  v_mov_b32_dpp v174, v170 row_ror:8 row_mask:0xf bank_mask:0x3
  v_mov_b32_dpp v175, v171 row_ror:8 row_mask:0xf bank_mask:0x3
  v_accvgpr_write_b32 a24, v96
  v_accvgpr_write_b32 a25, v97
  v_accvgpr_write_b32 a26, v98
  v_accvgpr_write_b32 a27, v99
  v_accvgpr_write_b32 a28, v172
  v_accvgpr_write_b32 a29, v173
  v_accvgpr_write_b32 a30, v174
  v_accvgpr_write_b32 a31, v175
  s_add_u32 s96, s77, 102400
  buffer_load_dwordx4 v[240:243], v32, s[8:11], s96 offen offset:0 nt
  v_mov_b32 v96, v176
  v_mov_b32 v97, v177
  v_mov_b32 v98, v178
  v_mov_b32 v99, v179
  v_mov_b32_dpp v96, v180 row_ror:8 row_mask:0xf bank_mask:0xc
  v_mov_b32_dpp v97, v181 row_ror:8 row_mask:0xf bank_mask:0xc
  v_mov_b32_dpp v98, v182 row_ror:8 row_mask:0xf bank_mask:0xc
  v_mov_b32_dpp v99, v183 row_ror:8 row_mask:0xf bank_mask:0xc
  v_mov_b32_dpp v180, v176 row_ror:8 row_mask:0xf bank_mask:0x3
  v_mov_b32_dpp v181, v177 row_ror:8 row_mask:0xf bank_mask:0x3
  buffer_load_dwordx4 v[244:247], v32, s[8:11], s96 offen offset:512 nt
  v_mov_b32_dpp v182, v178 row_ror:8 row_mask:0xf bank_mask:0x3
  v_mov_b32_dpp v183, v179 row_ror:8 row_mask:0xf bank_mask:0x3
  v_accvgpr_write_b32 a80, v96
  v_accvgpr_write_b32 a81, v97
  v_accvgpr_write_b32 a82, v98
  v_accvgpr_write_b32 a83, v99
  v_accvgpr_write_b32 a84, v180
  v_accvgpr_write_b32 a85, v181
  v_accvgpr_write_b32 a86, v182
  v_accvgpr_write_b32 a87, v183
  buffer_load_dwordx4 v[248:251], v32, s[8:11], s96 offen offset:128 nt
  v_mov_b32 v96, v184
  v_mov_b32 v97, v185
  v_mov_b32 v98, v186
  v_mov_b32 v99, v187
  v_mov_b32_dpp v96, v188 row_ror:8 row_mask:0xf bank_mask:0xc
  v_mov_b32_dpp v97, v189 row_ror:8 row_mask:0xf bank_mask:0xc
  v_mov_b32_dpp v98, v190 row_ror:8 row_mask:0xf bank_mask:0xc
  v_mov_b32_dpp v99, v191 row_ror:8 row_mask:0xf bank_mask:0xc
  v_mov_b32_dpp v188, v184 row_ror:8 row_mask:0xf bank_mask:0x3
  v_mov_b32_dpp v189, v185 row_ror:8 row_mask:0xf bank_mask:0x3
  buffer_load_dwordx4 v[252:255], v32, s[8:11], s96 offen offset:640 nt
  v_mov_b32_dpp v190, v186 row_ror:8 row_mask:0xf bank_mask:0x3
  v_mov_b32_dpp v191, v187 row_ror:8 row_mask:0xf bank_mask:0x3
  v_accvgpr_write_b32 a88, v96
  v_accvgpr_write_b32 a89, v97
  v_accvgpr_write_b32 a90, v98
  v_accvgpr_write_b32 a91, v99
  v_accvgpr_write_b32 a92, v188
  v_accvgpr_write_b32 a93, v189
  v_accvgpr_write_b32 a94, v190
  v_accvgpr_write_b32 a95, v191
  buffer_load_dwordx2 v[80:81], v36, s[48:51], 0 offen sc1
  s_waitcnt vmcnt(9)
  s_add_u32 s96, s77, 0
  buffer_load_dwordx4 v[128:131], v0, s[12:15], s96 offen offset:0 nt
  v_mov_b32 v96, v192
  v_mov_b32 v97, v193
  v_mov_b32 v98, v194
  v_mov_b32 v99, v195
  v_mov_b32_dpp v96, v196 row_ror:8 row_mask:0xf bank_mask:0xc
  v_mov_b32_dpp v97, v197 row_ror:8 row_mask:0xf bank_mask:0xc
  v_mov_b32_dpp v98, v198 row_ror:8 row_mask:0xf bank_mask:0xc
  v_mov_b32_dpp v99, v199 row_ror:8 row_mask:0xf bank_mask:0xc
  v_mov_b32_dpp v196, v192 row_ror:8 row_mask:0xf bank_mask:0x3
  v_mov_b32_dpp v197, v193 row_ror:8 row_mask:0xf bank_mask:0x3
  buffer_load_dwordx4 v[132:135], v0, s[12:15], s96 offen offset:1024 nt
  v_mov_b32_dpp v198, v194 row_ror:8 row_mask:0xf bank_mask:0x3
  v_mov_b32_dpp v199, v195 row_ror:8 row_mask:0xf bank_mask:0x3
  v_accvgpr_write_b32 a32, v96
  v_accvgpr_write_b32 a33, v97
  v_accvgpr_write_b32 a34, v98
  v_accvgpr_write_b32 a35, v99
  v_accvgpr_write_b32 a36, v196
  v_accvgpr_write_b32 a37, v197
  v_accvgpr_write_b32 a38, v198
  v_accvgpr_write_b32 a39, v199
  buffer_load_dwordx4 v[136:139], v0, s[12:15], s96 offen offset:2048 nt
  v_mov_b32 v96, v200
  v_mov_b32 v97, v201
  v_mov_b32 v98, v202
  v_mov_b32 v99, v203
  v_mov_b32_dpp v96, v204 row_ror:8 row_mask:0xf bank_mask:0xc
  v_mov_b32_dpp v97, v205 row_ror:8 row_mask:0xf bank_mask:0xc
  v_mov_b32_dpp v98, v206 row_ror:8 row_mask:0xf bank_mask:0xc
  v_mov_b32_dpp v99, v207 row_ror:8 row_mask:0xf bank_mask:0xc
  v_mov_b32_dpp v204, v200 row_ror:8 row_mask:0xf bank_mask:0x3
  v_mov_b32_dpp v205, v201 row_ror:8 row_mask:0xf bank_mask:0x3
  buffer_load_dwordx4 v[140:143], v0, s[12:15], s96 offen offset:3072 nt
  v_mov_b32_dpp v206, v202 row_ror:8 row_mask:0xf bank_mask:0x3
  v_mov_b32_dpp v207, v203 row_ror:8 row_mask:0xf bank_mask:0x3
  v_accvgpr_write_b32 a40, v96
  v_accvgpr_write_b32 a41, v97
  v_accvgpr_write_b32 a42, v98
  v_accvgpr_write_b32 a43, v99
  v_accvgpr_write_b32 a44, v204
  v_accvgpr_write_b32 a45, v205
  v_accvgpr_write_b32 a46, v206
  v_accvgpr_write_b32 a47, v207
  s_add_u32 s96, s77, 4096
  buffer_load_dwordx4 v[144:147], v0, s[12:15], s96 offen offset:0 nt
  v_mov_b32 v96, v208
  v_mov_b32 v97, v209
  v_mov_b32 v98, v210
  v_mov_b32 v99, v211
  v_mov_b32_dpp v96, v212 row_ror:8 row_mask:0xf bank_mask:0xc
  v_mov_b32_dpp v97, v213 row_ror:8 row_mask:0xf bank_mask:0xc
  v_mov_b32_dpp v98, v214 row_ror:8 row_mask:0xf bank_mask:0xc
  v_mov_b32_dpp v99, v215 row_ror:8 row_mask:0xf bank_mask:0xc
  v_mov_b32_dpp v212, v208 row_ror:8 row_mask:0xf bank_mask:0x3
  v_mov_b32_dpp v213, v209 row_ror:8 row_mask:0xf bank_mask:0x3
  buffer_load_dwordx4 v[148:151], v0, s[12:15], s96 offen offset:1024 nt
  v_mov_b32_dpp v214, v210 row_ror:8 row_mask:0xf bank_mask:0x3
  v_mov_b32_dpp v215, v211 row_ror:8 row_mask:0xf bank_mask:0x3
  v_accvgpr_write_b32 a96, v96
  v_accvgpr_write_b32 a97, v97
  v_accvgpr_write_b32 a98, v98
  v_accvgpr_write_b32 a99, v99
  v_accvgpr_write_b32 a100, v212
  v_accvgpr_write_b32 a101, v213
  v_accvgpr_write_b32 a102, v214
  v_accvgpr_write_b32 a103, v215
  buffer_load_dwordx4 v[152:155], v0, s[12:15], s96 offen offset:2048 nt
  v_mov_b32 v96, v216
  v_mov_b32 v97, v217
  v_mov_b32 v98, v218
  v_mov_b32 v99, v219
  v_mov_b32_dpp v96, v220 row_ror:8 row_mask:0xf bank_mask:0xc
  v_mov_b32_dpp v97, v221 row_ror:8 row_mask:0xf bank_mask:0xc
  v_mov_b32_dpp v98, v222 row_ror:8 row_mask:0xf bank_mask:0xc
  v_mov_b32_dpp v99, v223 row_ror:8 row_mask:0xf bank_mask:0xc
  v_mov_b32_dpp v220, v216 row_ror:8 row_mask:0xf bank_mask:0x3
  v_mov_b32_dpp v221, v217 row_ror:8 row_mask:0xf bank_mask:0x3
  buffer_load_dwordx4 v[156:159], v0, s[12:15], s96 offen offset:3072 nt
  v_mov_b32_dpp v222, v218 row_ror:8 row_mask:0xf bank_mask:0x3
  v_mov_b32_dpp v223, v219 row_ror:8 row_mask:0xf bank_mask:0x3
  v_accvgpr_write_b32 a104, v96
  v_accvgpr_write_b32 a105, v97
  v_accvgpr_write_b32 a106, v98
  v_accvgpr_write_b32 a107, v99
  v_accvgpr_write_b32 a108, v220
  v_accvgpr_write_b32 a109, v221
  v_accvgpr_write_b32 a110, v222
  v_accvgpr_write_b32 a111, v223
  s_waitcnt vmcnt(8)
L_bar_2:
  v_lshrrev_b32 v37, 16, v81
  v_cmp_gt_u32 vcc, 32, v37
  s_cbranch_vccz L_barok_3
  buffer_load_dwordx2 v[80:81], v36, s[48:51], 0 offen sc1
  s_waitcnt vmcnt(0)
  s_sub_u32 s76, s76, 1
  s_cbranch_scc0 L_bar_2
  s_mov_b32 s76, 0
L_barok_3:
  s_and_b32 s97, s2, 7
  s_waitcnt lgkmcnt(0)
  v_readlane_b32 s96, v80, s97
  v_readlane_b32 s97, v81, s97
  s_lshl_b64 s[100:101], 32, s7
  s_add_u32 s101, s101, 0x200000
  s_xor_b32 s96, s96, s100
  s_xor_b32 s97, s97, s101
  s_or_b32 s96, s96, s97
  s_cmp_eq_u32 s96, 0
  s_cselect_b32 s7, 1, 0
  s_mov_b32 exec_lo, 0x30003
  s_mov_b32 exec_hi, 0x30003
  s_cmp_eq_u32 s7, 1
  s_cbranch_scc0 L_wt_4
  buffer_store_dwordx2 v[60:61], v7, s[16:19], s79 offen
L_back_5:
  s_mov_b64 exec, -1
  s_add_u32 s95, s79, 0x21000
  s_mov_b32 exec_lo, 0x10001
  s_mov_b32 exec_hi, 0x10001
  s_cmp_eq_u32 s7, 1
  s_cbranch_scc0 L_wt_6
  buffer_store_dwordx2 v[24:25], v7, s[16:19], s95 offen
L_back_7:
  s_mov_b64 exec, -1
  v_lshrrev_b32 v37, 3, v0
  v_and_b32 v37, 32, v37
  v_xor_b32 v27, v4, v37
  s_and_b32 s100, s3, 1
  s_lshl_b32 s100, s100, 6
  v_xor_b32 v27, s100, v27
  v_lshrrev_b32 v37, 7, v0
  v_mul_u32_u24 v26, 3584, v37
  v_add_u32 v26, v26, v27
  v_lshl_add_u32 v27, v37, 10, v27
  s_bfe_u32 s42, s2, 0x30003
  s_mul_i32 s42, s42, 229376
  s_mul_i32 s100, s3, 28672
  s_add_u32 s42, s42, s100
  s_bfe_u32 s100, s2, 0x20006
  s_lshl_b32 s100, s100, 10
  s_add_u32 s42, s42, s100
  s_bfe_u32 s100, s2, 0x30000
  s_lshl_b32 s100, s100, 7
  s_add_u32 s42, s42, s100
  s_bfe_u32 s43, s2, 0x20006
  s_lshl_b32 s43, s43, 19
  s_bfe_u32 s100, s2, 0x30000
  s_lshl_b32 s100, s100, 16
  s_add_u32 s43, s43, s100
  s_lshl_b32 s100, s3, 13
  s_add_u32 s43, s43, s100
  s_bfe_u32 s100, s2, 0x30003
  s_lshl_b32 s100, s100, 7
  s_add_u32 s43, s43, s100
  s_bfe_u32 s41, s2, 0x10006
  s_lshl_b32 s41, s41, 12
  s_bfe_u32 s100, s2, 0x10007
  s_lshl_b32 s100, s100, 17
  s_add_u32 s41, s41, s100
  s_cmp_lt_u32 s5, 28
  s_cselect_b32 s41, s41, 0
  s_lshl_b32 s97, s3, 7
  s_add_u32 s97, s97, s4
  s_add_u32 s97, s97, 0x8000
  s_add_u32 s41, s41, s97
  s_add_u32 s95, s4, 0x2b000
  s_bfe_u32 s40, s2, 0x40003
  s_lshl_b32 s40, s40, 17
  s_bfe_u32 s100, s2, 0x30000
  s_lshl_b32 s100, s100, 13
  s_add_u32 s40, s40, s100
  s_bfe_u32 s100, s2, 0x10007
  s_lshl_b32 s100, s100, 12
  s_add_u32 s40, s40, s100
  s_lshl_b32 s100, s3, 10
  s_add_u32 s40, s40, s100
  s_add_u32 s40, s40, 0x10000
  s_add_u32 s96, s77, 32768
  buffer_load_dwordx4 v[160:163], v0, s[12:15], s96 offen offset:0 nt
  v_mov_b32 v96, v224
  v_mov_b32 v97, v225
  v_mov_b32 v98, v226
  v_mov_b32 v99, v227
  v_mov_b32_dpp v96, v228 row_ror:8 row_mask:0xf bank_mask:0xc
  v_mov_b32_dpp v97, v229 row_ror:8 row_mask:0xf bank_mask:0xc
  v_mov_b32_dpp v98, v230 row_ror:8 row_mask:0xf bank_mask:0xc
  v_mov_b32_dpp v99, v231 row_ror:8 row_mask:0xf bank_mask:0xc
  v_mov_b32_dpp v228, v224 row_ror:8 row_mask:0xf bank_mask:0x3
  v_mov_b32_dpp v229, v225 row_ror:8 row_mask:0xf bank_mask:0x3
  buffer_load_dwordx4 v[164:167], v0, s[12:15], s96 offen offset:1024 nt
  v_mov_b32_dpp v230, v226 row_ror:8 row_mask:0xf bank_mask:0x3
  v_mov_b32_dpp v231, v227 row_ror:8 row_mask:0xf bank_mask:0x3
  v_accvgpr_write_b32 a48, v96
  v_accvgpr_write_b32 a49, v97
  v_accvgpr_write_b32 a50, v98
  v_accvgpr_write_b32 a51, v99
  v_accvgpr_write_b32 a52, v228
  v_accvgpr_write_b32 a53, v229
  v_accvgpr_write_b32 a54, v230
  v_accvgpr_write_b32 a55, v231
  buffer_load_dwordx4 v[168:171], v0, s[12:15], s96 offen offset:2048 nt
  v_mov_b32 v96, v232
  v_mov_b32 v97, v233
  v_mov_b32 v98, v234
  v_mov_b32 v99, v235
  v_mov_b32_dpp v96, v236 row_ror:8 row_mask:0xf bank_mask:0xc
  v_mov_b32_dpp v97, v237 row_ror:8 row_mask:0xf bank_mask:0xc
  v_mov_b32_dpp v98, v238 row_ror:8 row_mask:0xf bank_mask:0xc
  v_mov_b32_dpp v99, v239 row_ror:8 row_mask:0xf bank_mask:0xc
  v_mov_b32_dpp v236, v232 row_ror:8 row_mask:0xf bank_mask:0x3
  v_mov_b32_dpp v237, v233 row_ror:8 row_mask:0xf bank_mask:0x3
  buffer_load_dwordx4 v[172:175], v0, s[12:15], s96 offen offset:3072 nt
  v_mov_b32_dpp v238, v234 row_ror:8 row_mask:0xf bank_mask:0x3
  v_mov_b32_dpp v239, v235 row_ror:8 row_mask:0xf bank_mask:0x3
  v_accvgpr_write_b32 a56, v96
  v_accvgpr_write_b32 a57, v97
  v_accvgpr_write_b32 a58, v98
  v_accvgpr_write_b32 a59, v99
  v_accvgpr_write_b32 a60, v236
  v_accvgpr_write_b32 a61, v237
  v_accvgpr_write_b32 a62, v238
  v_accvgpr_write_b32 a63, v239
  s_add_u32 s96, s77, 36864
  buffer_load_dwordx4 v[176:179], v0, s[12:15], s96 offen offset:0 nt
  v_mov_b32 v96, v240
  v_mov_b32 v97, v241
  v_mov_b32 v98, v242
  v_mov_b32 v99, v243
  v_mov_b32_dpp v96, v244 row_ror:8 row_mask:0xf bank_mask:0xc
  v_mov_b32_dpp v97, v245 row_ror:8 row_mask:0xf bank_mask:0xc
  v_mov_b32_dpp v98, v246 row_ror:8 row_mask:0xf bank_mask:0xc
  v_mov_b32_dpp v99, v247 row_ror:8 row_mask:0xf bank_mask:0xc
  v_mov_b32_dpp v244, v240 row_ror:8 row_mask:0xf bank_mask:0x3
  v_mov_b32_dpp v245, v241 row_ror:8 row_mask:0xf bank_mask:0x3
  buffer_load_dwordx4 v[180:183], v0, s[12:15], s96 offen offset:1024 nt
  v_mov_b32_dpp v246, v242 row_ror:8 row_mask:0xf bank_mask:0x3
  v_mov_b32_dpp v247, v243 row_ror:8 row_mask:0xf bank_mask:0x3
  v_accvgpr_write_b32 a112, v96
  v_accvgpr_write_b32 a113, v97
  v_accvgpr_write_b32 a114, v98
  v_accvgpr_write_b32 a115, v99
  v_accvgpr_write_b32 a116, v244
  v_accvgpr_write_b32 a117, v245
  v_accvgpr_write_b32 a118, v246
  v_accvgpr_write_b32 a119, v247
  buffer_load_dwordx4 v[184:187], v0, s[12:15], s96 offen offset:2048 nt
  v_mov_b32 v96, v248
  v_mov_b32 v97, v249
  v_mov_b32 v98, v250
  v_mov_b32 v99, v251
  v_mov_b32_dpp v96, v252 row_ror:8 row_mask:0xf bank_mask:0xc
  v_mov_b32_dpp v97, v253 row_ror:8 row_mask:0xf bank_mask:0xc
  v_mov_b32_dpp v98, v254 row_ror:8 row_mask:0xf bank_mask:0xc
  v_mov_b32_dpp v99, v255 row_ror:8 row_mask:0xf bank_mask:0xc
  v_mov_b32_dpp v252, v248 row_ror:8 row_mask:0xf bank_mask:0x3
  v_mov_b32_dpp v253, v249 row_ror:8 row_mask:0xf bank_mask:0x3
  buffer_load_dwordx4 v[188:191], v0, s[12:15], s96 offen offset:3072 nt
  v_mov_b32_dpp v254, v250 row_ror:8 row_mask:0xf bank_mask:0x3
  v_mov_b32_dpp v255, v251 row_ror:8 row_mask:0xf bank_mask:0x3
  v_accvgpr_write_b32 a120, v96
  v_accvgpr_write_b32 a121, v97
  v_accvgpr_write_b32 a122, v98
  v_accvgpr_write_b32 a123, v99
  v_accvgpr_write_b32 a124, v252
  v_accvgpr_write_b32 a125, v253
  v_accvgpr_write_b32 a126, v254
  v_accvgpr_write_b32 a127, v255
  buffer_load_dwordx4 v[28:31], v3, s[16:19], s78 offen offset:0 sc1
  buffer_load_dwordx4 v[32:35], v3, s[16:19], s78 offen offset:1024 sc1
  buffer_load_dwordx4 v[36:39], v3, s[16:19], s78 offen offset:2048 sc1
  buffer_load_dwordx4 v[40:43], v3, s[16:19], s78 offen offset:3072 sc1
  s_add_u32 s96, s77, 65536
  buffer_load_dwordx4 v[192:195], v0, s[12:15], s96 offen offset:0 nt
  buffer_load_dwordx4 v[196:199], v0, s[12:15], s96 offen offset:1024 nt
  buffer_load_dwordx4 v[200:203], v0, s[12:15], s96 offen offset:2048 nt
  buffer_load_dwordx4 v[204:207], v0, s[12:15], s96 offen offset:3072 nt
  s_add_u32 s96, s77, 69632
  buffer_load_dwordx4 v[208:211], v0, s[12:15], s96 offen offset:0 nt
  buffer_load_dwordx4 v[212:215], v0, s[12:15], s96 offen offset:1024 nt
  buffer_load_dwordx4 v[216:219], v0, s[12:15], s96 offen offset:2048 nt
  buffer_load_dwordx4 v[220:223], v0, s[12:15], s96 offen offset:3072 nt
  s_waitcnt vmcnt(8)
  s_branch L_chk_8
L_retry_9:
  s_sub_u32 s76, s76, 1
  s_cbranch_scc1 L_giveup_11
  s_mov_b64 exec, vcc
  buffer_load_dwordx4 v[28:31], v3, s[16:19], s78 offen offset:0 sc1
  buffer_load_dwordx4 v[32:35], v3, s[16:19], s78 offen offset:1024 sc1
  buffer_load_dwordx4 v[36:39], v3, s[16:19], s78 offen offset:2048 sc1
  buffer_load_dwordx4 v[40:43], v3, s[16:19], s78 offen offset:3072 sc1
  s_mov_b64 exec, -1
L_first_12:
  s_waitcnt vmcnt(0)
L_chk_8:
  v_max3_u32 v76, v28, v29, v30
  v_max3_u32 v77, v37, v38, v39
  v_max3_u32 v76, v31, v32, v76
  v_max3_u32 v77, v40, v41, v77
  v_max3_u32 v76, v33, v34, v76
  v_max3_u32 v77, v42, v43, v77
  v_max3_u32 v76, v35, v36, v76
  v_max_u32 v76, v76, v77
  v_cmp_eq_u32 vcc, -1, v76
  s_cbranch_vccnz L_retry_9
L_got_10:
  v_mov_b32 v78, 0
  v_mov_b32 v79, 0x3f85202e
  v_mfma_f32_16x16x32_bf16 v[44:47], a[0:3], v[28:31], 0
  v_mfma_f32_16x16x32_bf16 v[44:47], a[4:7], v[32:35], v[44:47]
  v_mfma_f32_16x16x32_bf16 v[44:47], a[8:11], v[36:39], v[44:47]
  v_mfma_f32_16x16x32_bf16 v[44:47], a[12:15], v[40:43], v[44:47]
  s_branch L_qk
L_tblk:
L_layer:
  s_waitcnt vmcnt(0)
  buffer_load_dwordx4 v[28:31], v3, s[16:19], s78 offen offset:0 sc1
  buffer_load_dwordx4 v[32:35], v3, s[16:19], s78 offen offset:1024 sc1
  buffer_load_dwordx4 v[36:39], v3, s[16:19], s78 offen offset:2048 sc1
  buffer_load_dwordx4 v[40:43], v3, s[16:19], s78 offen offset:3072 sc1
  buffer_load_dwordx2 v[78:79], v4, s[16:19], s89 offen sc1
  s_branch L_first_17
L_retry_14:
  s_sub_u32 s76, s76, 1
  s_cbranch_scc1 L_giveup_16
  s_mov_b64 exec, vcc
  buffer_load_dwordx4 v[28:31], v3, s[16:19], s78 offen offset:0 sc1
  buffer_load_dwordx4 v[32:35], v3, s[16:19], s78 offen offset:1024 sc1
  buffer_load_dwordx4 v[36:39], v3, s[16:19], s78 offen offset:2048 sc1
  buffer_load_dwordx4 v[40:43], v3, s[16:19], s78 offen offset:3072 sc1
  buffer_load_dwordx2 v[78:79], v4, s[16:19], s89 offen sc1
  s_mov_b64 exec, -1
L_first_17:
  s_waitcnt vmcnt(0)
L_chk_13:
  v_mfma_f32_16x16x32_bf16 v[44:47], a[0:3], v[28:31], 0
  v_max3_u32 v76, v28, v29, v30
  v_max3_u32 v77, v37, v38, v39
  v_mfma_f32_16x16x32_bf16 v[44:47], a[4:7], v[32:35], v[44:47]
  v_max3_u32 v76, v31, v32, v76
  v_max3_u32 v77, v40, v41, v77
  v_mfma_f32_16x16x32_bf16 v[44:47], a[8:11], v[36:39], v[44:47]
  v_max3_u32 v76, v33, v34, v76
  v_max3_u32 v77, v42, v43, v77
  v_mfma_f32_16x16x32_bf16 v[44:47], a[12:15], v[40:43], v[44:47]
  v_max3_u32 v76, v35, v36, v76
  v_max3_u32 v77, v78, v79, v77
  v_max_u32 v76, v76, v77
  v_cmp_eq_u32 vcc, -1, v76
  s_cbranch_vccnz L_retry_14
L_got_15:
L_qk:
  v_mfma_f32_16x16x32_bf16 v[52:55], a[32:35], v[28:31], 0
  v_mfma_f32_16x16x32_bf16 v[52:55], a[36:39], v[32:35], v[52:55]
  v_add_f32_dpp v78, v78, v78 quad_perm:[1,0,3,2] row_mask:0xf bank_mask:0xf
  v_add_f32_dpp v79, v79, v79 quad_perm:[1,0,3,2] row_mask:0xf bank_mask:0xf
  v_mfma_f32_16x16x32_bf16 v[52:55], a[40:43], v[36:39], v[52:55]
  v_add_f32_dpp v78, v78, v78 quad_perm:[2,3,0,1] row_mask:0xf bank_mask:0xf
  v_add_f32_dpp v79, v79, v79 quad_perm:[2,3,0,1] row_mask:0xf bank_mask:0xf
  v_mfma_f32_16x16x32_bf16 v[52:55], a[44:47], v[40:43], v[52:55]
  v_add_f32_dpp v78, v78, v78 row_ror:4 row_mask:0xf bank_mask:0xf
  v_add_f32_dpp v79, v79, v79 row_ror:4 row_mask:0xf bank_mask:0xf
  v_mfma_f32_16x16x32_bf16 v[48:51], a[16:19], v[28:31], 0
  v_mul_f32 v78, 0xbb000000, v78
  v_mul_f32 v79, 0x3b000000, v79
  v_mfma_f32_16x16x32_bf16 v[48:51], a[20:23], v[32:35], v[48:51]
  v_fma_f32 v79, -v78, v78, v79
  v_max_f32 v79, 0, v79
  v_mfma_f32_16x16x32_bf16 v[48:51], a[24:27], v[36:39], v[48:51]
  v_add_f32 v79, 0x3727c5ac, v79
  v_rsq_f32 v79, v79
  v_mfma_f32_16x16x32_bf16 v[48:51], a[28:31], v[40:43], v[48:51]
  v_add_f32_dpp v80, v44, v44 row_ror:8 row_mask:0xf bank_mask:0x3
  v_add_f32_dpp v81, v45, v45 row_ror:8 row_mask:0xf bank_mask:0x3
  v_mfma_f32_16x16x32_bf16 v[56:59], a[48:51], v[28:31], 0
  v_add_f32_dpp v82, v46, v46 row_ror:8 row_mask:0xf bank_mask:0x3
  v_add_f32_dpp v83, v47, v47 row_ror:8 row_mask:0xf bank_mask:0x3
  v_mfma_f32_16x16x32_bf16 v[56:59], a[52:55], v[32:35], v[56:59]
  v_add_f32_dpp v80, v52, v52 row_ror:8 row_mask:0xf bank_mask:0xc
  v_add_f32_dpp v81, v53, v53 row_ror:8 row_mask:0xf bank_mask:0xc
  v_mfma_f32_16x16x32_bf16 v[56:59], a[56:59], v[36:39], v[56:59]
  v_add_f32_dpp v82, v54, v54 row_ror:8 row_mask:0xf bank_mask:0xc
  v_add_f32_dpp v83, v55, v55 row_ror:8 row_mask:0xf bank_mask:0xc
  v_mfma_f32_16x16x32_bf16 v[56:59], a[60:63], v[40:43], v[56:59]
  v_add_f32_dpp v88, v80, v80 row_ror:12 row_mask:0xf bank_mask:0x5
  v_add_f32_dpp v89, v81, v81 row_ror:12 row_mask:0xf bank_mask:0x5
  v_mfma_f32_16x16x32_bf16 v[60:63], a[64:67], v[28:31], 0
  v_add_f32_dpp v90, v82, v82 row_ror:12 row_mask:0xf bank_mask:0x5
  v_add_f32_dpp v91, v83, v83 row_ror:12 row_mask:0xf bank_mask:0x5
  v_mfma_f32_16x16x32_bf16 v[60:63], a[68:71], v[32:35], v[60:63]
  v_add_f32_dpp v84, v48, v48 row_ror:8 row_mask:0xf bank_mask:0x3
  v_add_f32_dpp v85, v49, v49 row_ror:8 row_mask:0xf bank_mask:0x3
  v_mfma_f32_16x16x32_bf16 v[60:63], a[72:75], v[36:39], v[60:63]
  v_add_f32_dpp v86, v50, v50 row_ror:8 row_mask:0xf bank_mask:0x3
  v_add_f32_dpp v87, v51, v51 row_ror:8 row_mask:0xf bank_mask:0x3
  v_mfma_f32_16x16x32_bf16 v[60:63], a[76:79], v[40:43], v[60:63]
  v_add_f32_dpp v84, v56, v56 row_ror:8 row_mask:0xf bank_mask:0xc
  v_add_f32_dpp v85, v57, v57 row_ror:8 row_mask:0xf bank_mask:0xc
  v_mfma_f32_16x16x32_bf16 v[68:71], a[96:99], v[28:31], 0
  v_add_f32_dpp v86, v58, v58 row_ror:8 row_mask:0xf bank_mask:0xc
  v_add_f32_dpp v87, v59, v59 row_ror:8 row_mask:0xf bank_mask:0xc
  v_mfma_f32_16x16x32_bf16 v[68:71], a[100:103], v[32:35], v[68:71]
  v_add_f32_dpp v88, v84, v84 row_ror:4 row_mask:0xf bank_mask:0xa
  v_add_f32_dpp v89, v85, v85 row_ror:4 row_mask:0xf bank_mask:0xa
  v_mfma_f32_16x16x32_bf16 v[68:71], a[104:107], v[36:39], v[68:71]
  v_add_f32_dpp v90, v86, v86 row_ror:4 row_mask:0xf bank_mask:0xa
  v_add_f32_dpp v91, v87, v87 row_ror:4 row_mask:0xf bank_mask:0xa
  v_mfma_f32_16x16x32_bf16 v[68:71], a[108:111], v[40:43], v[68:71]
  v_mul_f32 v79, 0x3e0293ee, v79
  s_nop 0
  v_mfma_f32_16x16x32_bf16 v[64:67], a[80:83], v[28:31], 0
  v_add_f32_dpp v80, v60, v60 row_ror:8 row_mask:0xf bank_mask:0x3
  v_add_f32_dpp v81, v61, v61 row_ror:8 row_mask:0xf bank_mask:0x3
  v_mfma_f32_16x16x32_bf16 v[64:67], a[84:87], v[32:35], v[64:67]
  v_add_f32_dpp v82, v62, v62 row_ror:8 row_mask:0xf bank_mask:0x3
  v_add_f32_dpp v83, v63, v63 row_ror:8 row_mask:0xf bank_mask:0x3
  v_mfma_f32_16x16x32_bf16 v[64:67], a[88:91], v[36:39], v[64:67]
  v_add_f32_dpp v80, v68, v68 row_ror:8 row_mask:0xf bank_mask:0xc
  v_add_f32_dpp v81, v69, v69 row_ror:8 row_mask:0xf bank_mask:0xc
  v_mfma_f32_16x16x32_bf16 v[64:67], a[92:95], v[40:43], v[64:67]
  v_add_f32_dpp v82, v70, v70 row_ror:8 row_mask:0xf bank_mask:0xc
  v_add_f32_dpp v83, v71, v71 row_ror:8 row_mask:0xf bank_mask:0xc
  v_mfma_f32_16x16x32_bf16 v[72:75], a[112:115], v[28:31], 0
  v_add_f32_dpp v92, v80, v80 row_ror:12 row_mask:0xf bank_mask:0x5
  v_add_f32_dpp v93, v81, v81 row_ror:12 row_mask:0xf bank_mask:0x5
  v_mfma_f32_16x16x32_bf16 v[72:75], a[116:119], v[32:35], v[72:75]
  v_add_f32_dpp v94, v82, v82 row_ror:12 row_mask:0xf bank_mask:0x5
  v_add_f32_dpp v95, v83, v83 row_ror:12 row_mask:0xf bank_mask:0x5
  v_mfma_f32_16x16x32_bf16 v[72:75], a[120:123], v[36:39], v[72:75]
  v_add_f32_dpp v84, v64, v64 row_ror:8 row_mask:0xf bank_mask:0x3
  v_add_f32_dpp v85, v65, v65 row_ror:8 row_mask:0xf bank_mask:0x3
  v_mfma_f32_16x16x32_bf16 v[72:75], a[124:127], v[40:43], v[72:75]
  v_add_f32_dpp v86, v66, v66 row_ror:8 row_mask:0xf bank_mask:0x3
  v_add_f32_dpp v87, v67, v67 row_ror:8 row_mask:0xf bank_mask:0x3
  s_cmp_eq_u32 s6, 0
  s_cbranch_scc1 L_join_19
  v_fmac_f32 v88, v78, v232
  v_fmac_f32 v89, v78, v233
  v_fmac_f32 v90, v78, v234
  v_fmac_f32 v91, v78, v235
L_join_19:
  s_nop 3
  v_add_f32_dpp v84, v72, v72 row_ror:8 row_mask:0xf bank_mask:0xc
  v_add_f32_dpp v85, v73, v73 row_ror:8 row_mask:0xf bank_mask:0xc
  v_add_f32_dpp v86, v74, v74 row_ror:8 row_mask:0xf bank_mask:0xc
  v_add_f32_dpp v87, v75, v75 row_ror:8 row_mask:0xf bank_mask:0xc
  v_max3_f32 v76, v88, v89, v90
  v_add_f32_dpp v92, v84, v84 row_ror:4 row_mask:0xf bank_mask:0xa
  v_add_f32_dpp v93, v85, v85 row_ror:4 row_mask:0xf bank_mask:0xa
  v_add_f32_dpp v94, v86, v86 row_ror:4 row_mask:0xf bank_mask:0xa
  v_add_f32_dpp v95, v87, v87 row_ror:4 row_mask:0xf bank_mask:0xa
  s_cbranch_scc1 L_join_20
  v_fmac_f32 v92, v78, v236
  v_fmac_f32 v93, v78, v237
  v_fmac_f32 v94, v78, v238
  v_fmac_f32 v95, v78, v239
L_join_20:
  v_max3_f32 v76, v91, v92, v76
  v_max3_f32 v77, v93, v94, v95
  v_max_f32 v76, v77, v76
  s_nop 1
  v_max_f32_dpp v76, v76, v76 row_ror:4 row_mask:0xf bank_mask:0xf
  s_nop 1
  v_max_f32_dpp v76, v76, v76 row_ror:8 row_mask:0xf bank_mask:0xf
  v_mov_b32 v78, v76
  s_nop 1
  v_permlane16_swap_b32 v76, v78
  v_max_f32 v76, v76, v78
  v_mov_b32 v78, v76
  s_nop 1
  v_permlane32_swap_b32 v76, v78
  v_max_f32 v76, v76, v78
  v_mul_f32 v76, v76, v79
  v_fma_f32 v88, v88, v79, -v76
  v_fma_f32 v89, v89, v79, -v76
  v_fma_f32 v90, v90, v79, -v76
  v_fma_f32 v91, v91, v79, -v76
  v_fma_f32 v92, v92, v79, -v76
  v_fma_f32 v93, v93, v79, -v76
  v_fma_f32 v94, v94, v79, -v76
  v_fma_f32 v95, v95, v79, -v76
  v_exp_f32 v88, v88
  v_exp_f32 v89, v89
  v_exp_f32 v90, v90
  v_exp_f32 v91, v91
  v_exp_f32 v92, v92
  v_exp_f32 v93, v93
  v_exp_f32 v94, v94
  v_exp_f32 v95, v95
  v_cvt_pk_bf16_f32 v80, v88, v89
  v_cvt_pk_bf16_f32 v81, v90, v91
  v_cvt_pk_bf16_f32 v82, v92, v93
  v_cvt_pk_bf16_f32 v83, v94, v95
  s_cmp_eq_u32 s6, 0
  s_cbranch_scc0 L_join_22
  s_add_u32 s96, s77, 98304
  buffer_load_dwordx4 v[224:227], v0, s[12:15], s96 offen offset:0 nt
  buffer_load_dwordx4 v[228:231], v0, s[12:15], s96 offen offset:1024 nt
  buffer_load_dwordx4 v[232:235], v0, s[12:15], s96 offen offset:2048 nt
  buffer_load_dwordx4 v[236:239], v0, s[12:15], s96 offen offset:3072 nt
  s_add_u32 s96, s77, 102400
  buffer_load_dwordx4 v[240:243], v0, s[12:15], s96 offen offset:0 nt
  buffer_load_dwordx4 v[244:247], v0, s[12:15], s96 offen offset:1024 nt
  buffer_load_dwordx4 v[248:251], v0, s[12:15], s96 offen offset:2048 nt
  buffer_load_dwordx4 v[252:255], v0, s[12:15], s96 offen offset:3072 nt
  v_perm_b32 v96, v132, v128, s98
  v_perm_b32 v100, v132, v128, s99
  v_perm_b32 v104, v133, v129, s98
  v_perm_b32 v108, v133, v129, s99
  v_perm_b32 v112, v134, v130, s98
  v_perm_b32 v116, v134, v130, s99
  v_perm_b32 v120, v135, v131, s98
  v_perm_b32 v124, v135, v131, s99
  v_perm_b32 v97, v140, v136, s98
  v_perm_b32 v101, v140, v136, s99
  v_perm_b32 v105, v141, v137, s98
  v_perm_b32 v109, v141, v137, s99
  v_perm_b32 v113, v142, v138, s98
  v_perm_b32 v117, v142, v138, s99
  v_perm_b32 v121, v143, v139, s98
  v_perm_b32 v125, v143, v139, s99
  v_perm_b32 v98, v148, v144, s98
  v_perm_b32 v102, v148, v144, s99
  v_perm_b32 v106, v149, v145, s98
  v_perm_b32 v110, v149, v145, s99
  v_perm_b32 v114, v150, v146, s98
  v_perm_b32 v118, v150, v146, s99
  v_perm_b32 v122, v151, v147, s98
  v_perm_b32 v126, v151, v147, s99
  v_perm_b32 v99, v156, v152, s98
  v_perm_b32 v103, v156, v152, s99
  v_perm_b32 v107, v157, v153, s98
  v_perm_b32 v111, v157, v153, s99
  v_perm_b32 v115, v158, v154, s98
  v_perm_b32 v119, v158, v154, s99
  v_perm_b32 v123, v159, v155, s98
  v_perm_b32 v127, v159, v155, s99
  v_perm_b32 v128, v164, v160, s98
  v_perm_b32 v132, v164, v160, s99
  v_perm_b32 v136, v165, v161, s98
  v_perm_b32 v140, v165, v161, s99
  v_perm_b32 v144, v166, v162, s98
  v_perm_b32 v148, v166, v162, s99
  v_perm_b32 v152, v167, v163, s98
  v_perm_b32 v156, v167, v163, s99
  v_perm_b32 v129, v172, v168, s98
  v_perm_b32 v133, v172, v168, s99
  v_perm_b32 v137, v173, v169, s98
  v_perm_b32 v141, v173, v169, s99
  v_perm_b32 v145, v174, v170, s98
  v_perm_b32 v149, v174, v170, s99
  v_perm_b32 v153, v175, v171, s98
  v_perm_b32 v157, v175, v171, s99
  v_perm_b32 v130, v180, v176, s98
  v_perm_b32 v134, v180, v176, s99
  v_perm_b32 v138, v181, v177, s98
  v_perm_b32 v142, v181, v177, s99
  v_perm_b32 v146, v182, v178, s98
  v_perm_b32 v150, v182, v178, s99
  v_perm_b32 v154, v183, v179, s98
  v_perm_b32 v158, v183, v179, s99
  v_perm_b32 v131, v188, v184, s98
  v_perm_b32 v135, v188, v184, s99
  v_perm_b32 v139, v189, v185, s98
  v_perm_b32 v143, v189, v185, s99
  v_perm_b32 v147, v190, v186, s98
  v_perm_b32 v151, v190, v186, s99
  v_perm_b32 v155, v191, v187, s98
  v_perm_b32 v159, v191, v187, s99
L_join_22:
  v_mfma_f32_16x16x32_bf16 v[44:47], v[96:99], v[80:83], 0
  v_add_f32 v88, v88, v89
  v_add_f32 v90, v90, v91
  v_mfma_f32_16x16x32_bf16 v[48:51], v[100:103], v[80:83], 0
  v_add_f32 v92, v92, v93
  v_add_f32 v94, v94, v95
  v_mfma_f32_16x16x32_bf16 v[52:55], v[104:107], v[80:83], 0
  v_add_f32 v88, v88, v90
  v_add_f32 v92, v92, v94
  v_mfma_f32_16x16x32_bf16 v[56:59], v[108:111], v[80:83], 0
  v_add_f32 v77, v88, v92
  v_mov_b32_dpp v84, v80 row_ror:12 row_mask:0xf bank_mask:0xf
  v_mfma_f32_16x16x32_bf16 v[60:63], v[112:115], v[80:83], 0
  v_add_f32_dpp v77, v77, v77 row_ror:4 row_mask:0xf bank_mask:0xf
  v_mov_b32_dpp v85, v81 row_ror:12 row_mask:0xf bank_mask:0xf
  v_mfma_f32_16x16x32_bf16 v[64:67], v[116:119], v[80:83], 0
  v_add_f32_dpp v77, v77, v77 row_ror:8 row_mask:0xf bank_mask:0xf
  v_mov_b32_dpp v86, v82 row_ror:12 row_mask:0xf bank_mask:0xf
  v_mfma_f32_16x16x32_bf16 v[68:71], v[120:123], v[80:83], 0
  v_mov_b32 v78, v77
  v_mov_b32_dpp v87, v83 row_ror:12 row_mask:0xf bank_mask:0xf
  v_mfma_f32_16x16x32_bf16 v[72:75], v[124:127], v[80:83], 0
  v_permlane16_swap_b32 v77, v78
  v_add_f32 v77, v77, v78
  v_mfma_f32_16x16x32_bf16 v[44:47], v[128:131], v[84:87], v[44:47]
  v_mov_b32 v78, v77
  v_mov_b32_dpp v28, v80 row_ror:8 row_mask:0xf bank_mask:0xf
  v_mfma_f32_16x16x32_bf16 v[48:51], v[132:135], v[84:87], v[48:51]
  v_permlane32_swap_b32 v77, v78
  v_add_f32 v77, v77, v78
  v_mfma_f32_16x16x32_bf16 v[52:55], v[136:139], v[84:87], v[52:55]
  s_mov_b64 exec, 15
  ds_write_b64 v13, v[76:77]
  s_mov_b64 exec, -1
  v_mfma_f32_16x16x32_bf16 v[56:59], v[140:143], v[84:87], v[56:59]
  v_mov_b32_dpp v29, v81 row_ror:8 row_mask:0xf bank_mask:0xf
  v_mov_b32_dpp v30, v82 row_ror:8 row_mask:0xf bank_mask:0xf
  v_mfma_f32_16x16x32_bf16 v[60:63], v[144:147], v[84:87], v[60:63]
  v_mov_b32_dpp v31, v83 row_ror:8 row_mask:0xf bank_mask:0xf
  v_mov_b32_dpp v32, v80 row_ror:4 row_mask:0xf bank_mask:0xf
  v_mfma_f32_16x16x32_bf16 v[64:67], v[148:151], v[84:87], v[64:67]
  v_mov_b32_dpp v33, v81 row_ror:4 row_mask:0xf bank_mask:0xf
  v_mov_b32_dpp v34, v82 row_ror:4 row_mask:0xf bank_mask:0xf
  v_mfma_f32_16x16x32_bf16 v[68:71], v[152:155], v[84:87], v[68:71]
  s_waitcnt lgkmcnt(0)
  s_barrier
  ds_read_b128 v[88:91], v14
  ds_read_b128 v[92:95], v14 offset:16
  v_mfma_f32_16x16x32_bf16 v[72:75], v[156:159], v[84:87], v[72:75]
  v_mov_b32_dpp v35, v83 row_ror:4 row_mask:0xf bank_mask:0xf
  s_cmp_eq_u32 s6, 0
  s_cbranch_scc0 L_join_24
  v_lshrrev_b32 v79, 3, v0
  v_and_b32 v79, 32, v79
  v_xor_b32 v78, v4, v79
  s_and_b32 s100, s3, 1
  s_lshl_b32 s100, s100, 6
  v_xor_b32 v78, s100, v78
  v_lshrrev_b32 v79, 7, v0
  v_lshl_add_u32 v78, v79, 10, v78
  s_bfe_u32 s96, s2, 0x30000
  s_lshl_b32 s96, s96, 19
  s_bfe_u32 s100, s2, 0x20006
  s_lshl_b32 s100, s100, 17
  s_add_u32 s96, s96, s100
  s_lshl_b32 s100, s3, 13
  s_add_u32 s96, s96, s100
  s_bfe_u32 s100, s2, 0x30003
  s_lshl_b32 s100, s100, 7
  s_add_u32 s96, s96, s100
  s_lshl_b32 s100, s3, 10
  s_add_u32 m0, s100, 16384
  s_nop 0
  buffer_load_dwordx4 v78, s[24:27], s96 offen nt lds
  s_lshl_b32 s100, s3, 10
  s_add_u32 m0, s100, 20480
  s_add_u32 s96, s96, 32768
  buffer_load_dwordx4 v78, s[24:27], s96 offen nt lds
  s_lshl_b32 s100, s3, 10
  s_add_u32 m0, s100, 24576
  s_add_u32 s96, s96, 32768
  buffer_load_dwordx4 v78, s[24:27], s96 offen nt lds
  s_lshl_b32 s100, s3, 10
  s_add_u32 m0, s100, 28672
  s_add_u32 s96, s96, 32768
  buffer_load_dwordx4 v78, s[24:27], s96 offen nt lds
  s_waitcnt vmcnt(12)
  v_perm_b32 v160, v196, v192, s98
  v_perm_b32 v164, v196, v192, s99
  v_perm_b32 v168, v197, v193, s98
  v_perm_b32 v172, v197, v193, s99
  v_perm_b32 v176, v198, v194, s98
  v_perm_b32 v180, v198, v194, s99
  v_perm_b32 v184, v199, v195, s98
  v_perm_b32 v188, v199, v195, s99
  v_perm_b32 v161, v204, v200, s98
  v_perm_b32 v165, v204, v200, s99
  v_perm_b32 v169, v205, v201, s98
  v_perm_b32 v173, v205, v201, s99
  v_perm_b32 v177, v206, v202, s98
  v_perm_b32 v181, v206, v202, s99
  v_perm_b32 v185, v207, v203, s98
  v_perm_b32 v189, v207, v203, s99
  v_perm_b32 v162, v212, v208, s98
  v_perm_b32 v166, v212, v208, s99
  v_perm_b32 v170, v213, v209, s98
  v_perm_b32 v174, v213, v209, s99
  v_perm_b32 v178, v214, v210, s98
  v_perm_b32 v182, v214, v210, s99
  v_perm_b32 v186, v215, v211, s98
  v_perm_b32 v190, v215, v211, s99
  v_perm_b32 v163, v220, v216, s98
  v_perm_b32 v167, v220, v216, s99
  v_perm_b32 v171, v221, v217, s98
  v_perm_b32 v175, v221, v217, s99
  v_perm_b32 v179, v222, v218, s98
  v_perm_b32 v183, v222, v218, s99
  v_perm_b32 v187, v223, v219, s98
  v_perm_b32 v191, v223, v219, s99
L_join_24:
  v_mfma_f32_16x16x32_bf16 v[44:47], v[160:163], v[28:31], v[44:47]
  v_mfma_f32_16x16x32_bf16 v[48:51], v[164:167], v[28:31], v[48:51]
  v_mfma_f32_16x16x32_bf16 v[52:55], v[168:171], v[28:31], v[52:55]
  s_waitcnt lgkmcnt(0)
  v_max3_f32 v40, v88, v90, v92
  v_mfma_f32_16x16x32_bf16 v[56:59], v[172:175], v[28:31], v[56:59]
  v_max_f32 v40, v94, v40
  v_sub_f32 v36, v88, v40
  v_mfma_f32_16x16x32_bf16 v[60:63], v[176:179], v[28:31], v[60:63]
  v_sub_f32 v37, v90, v40
  v_sub_f32 v38, v92, v40
  v_mfma_f32_16x16x32_bf16 v[64:67], v[180:183], v[28:31], v[64:67]
  v_sub_f32 v39, v94, v40
  v_exp_f32 v36, v36
  v_mfma_f32_16x16x32_bf16 v[68:71], v[184:187], v[28:31], v[68:71]
  v_exp_f32 v37, v37
  v_exp_f32 v38, v38
  v_mfma_f32_16x16x32_bf16 v[72:75], v[188:191], v[28:31], v[72:75]
  v_exp_f32 v39, v39
  v_mul_f32 v41, v36, v89
  s_cmp_eq_u32 s6, 0
  s_cbranch_scc0 L_join_26
  s_waitcnt vmcnt(10)
  v_perm_b32 v192, v228, v224, s98
  v_perm_b32 v196, v228, v224, s99
  v_perm_b32 v200, v229, v225, s98
  v_perm_b32 v204, v229, v225, s99
  v_perm_b32 v208, v230, v226, s98
  v_perm_b32 v212, v230, v226, s99
  v_perm_b32 v216, v231, v227, s98
  v_perm_b32 v220, v231, v227, s99
  s_waitcnt vmcnt(8)
  v_perm_b32 v193, v236, v232, s98
  v_perm_b32 v197, v236, v232, s99
  v_perm_b32 v201, v237, v233, s98
  v_perm_b32 v205, v237, v233, s99
  v_perm_b32 v209, v238, v234, s98
  v_perm_b32 v213, v238, v234, s99
  v_perm_b32 v217, v239, v235, s98
  v_perm_b32 v221, v239, v235, s99
  s_waitcnt vmcnt(6)
  v_perm_b32 v194, v244, v240, s98
  v_perm_b32 v198, v244, v240, s99
  v_perm_b32 v202, v245, v241, s98
  v_perm_b32 v206, v245, v241, s99
  v_perm_b32 v210, v246, v242, s98
  v_perm_b32 v214, v246, v242, s99
  v_perm_b32 v218, v247, v243, s98
  v_perm_b32 v222, v247, v243, s99
  s_waitcnt vmcnt(4)
  v_perm_b32 v195, v252, v248, s98
  v_perm_b32 v199, v252, v248, s99
  v_perm_b32 v203, v253, v249, s98
  v_perm_b32 v207, v253, v249, s99
  v_perm_b32 v211, v254, v250, s98
  v_perm_b32 v215, v254, v250, s99
  v_perm_b32 v219, v255, v251, s98
  v_perm_b32 v223, v255, v251, s99
L_join_26:
  v_mfma_f32_16x16x32_bf16 v[44:47], v[192:195], v[32:35], v[44:47]
  v_fmac_f32 v41, v37, v91
  v_fmac_f32 v41, v38, v93
  v_mfma_f32_16x16x32_bf16 v[48:51], v[196:199], v[32:35], v[48:51]
  v_fmac_f32 v41, v39, v95
  v_rcp_f32 v42, v41
  v_mfma_f32_16x16x32_bf16 v[52:55], v[200:203], v[32:35], v[52:55]
  v_log_f32 v43, v41
  v_mul_f32 v36, v36, v42
  v_mfma_f32_16x16x32_bf16 v[56:59], v[204:207], v[32:35], v[56:59]
  v_mul_f32 v37, v37, v42
  v_mul_f32 v38, v38, v42
  v_mfma_f32_16x16x32_bf16 v[60:63], v[208:211], v[32:35], v[60:63]
  v_mul_f32 v39, v39, v42
  v_add_f32 v43, v43, v40
  v_mfma_f32_16x16x32_bf16 v[64:67], v[212:215], v[32:35], v[64:67]
  v_mov_b32_dpp v44, v52 row_ror:4 row_mask:0xf bank_mask:0x2
  v_mov_b32_dpp v45, v53 row_ror:4 row_mask:0xf bank_mask:0x2
  v_mfma_f32_16x16x32_bf16 v[68:71], v[216:219], v[32:35], v[68:71]
  v_mov_b32_dpp v46, v54 row_ror:4 row_mask:0xf bank_mask:0x2
  v_mov_b32_dpp v47, v55 row_ror:4 row_mask:0xf bank_mask:0x2
  v_mfma_f32_16x16x32_bf16 v[72:75], v[220:223], v[32:35], v[72:75]
  v_mov_b32_dpp v48, v56 row_ror:4 row_mask:0xf bank_mask:0x2
  v_mov_b32_dpp v49, v57 row_ror:4 row_mask:0xf bank_mask:0x2
  v_mov_b32_dpp v50, v58 row_ror:4 row_mask:0xf bank_mask:0x2
  v_mov_b32_dpp v51, v59 row_ror:4 row_mask:0xf bank_mask:0x2
  v_mov_b32_dpp v44, v60 row_ror:8 row_mask:0xf bank_mask:0x4
  v_mov_b32_dpp v45, v61 row_ror:8 row_mask:0xf bank_mask:0x4
  v_mov_b32_dpp v46, v62 row_ror:8 row_mask:0xf bank_mask:0x4
  v_mov_b32_dpp v47, v63 row_ror:8 row_mask:0xf bank_mask:0x4
  v_mov_b32_dpp v48, v64 row_ror:8 row_mask:0xf bank_mask:0x4
  v_mov_b32_dpp v49, v65 row_ror:8 row_mask:0xf bank_mask:0x4
  v_mov_b32_dpp v50, v66 row_ror:8 row_mask:0xf bank_mask:0x4
  v_mov_b32_dpp v51, v67 row_ror:8 row_mask:0xf bank_mask:0x4
  v_mov_b32_dpp v44, v68 row_ror:12 row_mask:0xf bank_mask:0x8
  v_mov_b32_dpp v45, v69 row_ror:12 row_mask:0xf bank_mask:0x8
  v_mov_b32_dpp v46, v70 row_ror:12 row_mask:0xf bank_mask:0x8
  v_mov_b32_dpp v47, v71 row_ror:12 row_mask:0xf bank_mask:0x8
  v_mov_b32_dpp v48, v72 row_ror:12 row_mask:0xf bank_mask:0x8
  v_mov_b32_dpp v49, v73 row_ror:12 row_mask:0xf bank_mask:0x8
  v_mov_b32_dpp v50, v74 row_ror:12 row_mask:0xf bank_mask:0x8
  v_mov_b32_dpp v51, v75 row_ror:12 row_mask:0xf bank_mask:0x8
  ds_write_b128 v11, v[44:47]
  ds_write_b128 v11, v[48:51] offset:1024
  s_mov_b64 exec, 1
  s_cmp_eq_u32 s7, 1
  s_cbranch_scc0 L_wt_27
  buffer_store_dword v43, off, s[16:19], s81
L_back_28:
  s_mov_b64 exec, -1
  s_waitcnt lgkmcnt(0)
  s_barrier
  ds_read2st64_b32 v[88:89], v12 offset0:0 offset1:4
  ds_read2st64_b32 v[90:91], v12 offset0:8 offset1:12
  ds_read2st64_b32 v[92:93], v12 offset0:16 offset1:20
  ds_read2st64_b32 v[94:95], v12 offset0:24 offset1:28
  s_waitcnt lgkmcnt(3)
  v_mul_f32 v88, v36, v88
  v_mul_f32 v89, v36, v89
  s_waitcnt lgkmcnt(2)
  v_fmac_f32 v88, v37, v90
  v_fmac_f32 v89, v37, v91
  s_waitcnt lgkmcnt(1)
  v_fmac_f32 v88, v38, v92
  v_fmac_f32 v89, v38, v93
  s_waitcnt lgkmcnt(0)
  v_fmac_f32 v88, v39, v94
  v_fmac_f32 v89, v39, v95
  v_cvt_pk_bf16_f32 v88, v88, v89
  s_cmp_eq_u32 s7, 1
  s_cbranch_scc0 L_wt_29
  buffer_store_dword v88, v2, s[16:19], s80 offen
L_back_30:
  s_cmp_eq_u32 s6, 0
  s_cbranch_scc0 L_join_37
  s_waitcnt vmcnt(0)
  buffer_load_dwordx4 v[28:31], v3, s[16:19], s82 offen offset:0 sc1
  buffer_load_dwordx4 v[32:35], v3, s[16:19], s82 offen offset:1024 sc1
  buffer_load_dwordx4 v[36:39], v3, s[16:19], s82 offen offset:2048 sc1
  buffer_load_dwordx4 v[40:43], v3, s[16:19], s82 offen offset:3072 sc1
  buffer_load_dwordx4 v[44:47], v6, s[16:19], s83 offen sc1
  s_and_b32 s96, s3, 1
  s_lshl_b32 s96, s96, 5
  v_xor_b32 v56, s96, v17
  v_xor_b32 v57, 32, v56
  s_barrier
  ds_read_b64_tr_b16 a[144:145], v56 offset:16384
  ds_read_b64_tr_b16 a[146:147], v56 offset:16896
  ds_read_b64_tr_b16 a[148:149], v56 offset:20480
  ds_read_b64_tr_b16 a[150:151], v56 offset:20992
  ds_read_b64_tr_b16 a[152:153], v56 offset:24576
  ds_read_b64_tr_b16 a[154:155], v56 offset:25088
  ds_read_b64_tr_b16 a[156:157], v56 offset:28672
  ds_read_b64_tr_b16 a[158:159], v56 offset:29184
  ds_read_b64_tr_b16 a[160:161], v57 offset:16384
  ds_read_b64_tr_b16 a[162:163], v57 offset:16896
  ds_read_b64_tr_b16 a[164:165], v57 offset:20480
  ds_read_b64_tr_b16 a[166:167], v57 offset:20992
  ds_read_b64_tr_b16 a[168:169], v57 offset:24576
  ds_read_b64_tr_b16 a[170:171], v57 offset:25088
  ds_read_b64_tr_b16 a[172:173], v57 offset:28672
  ds_read_b64_tr_b16 a[174:175], v57 offset:29184
  s_waitcnt lgkmcnt(0)
  s_branch L_first_35
L_join_37:
  s_waitcnt vmcnt(0)
  buffer_load_dwordx4 v[28:31], v3, s[16:19], s82 offen offset:0 sc1
  buffer_load_dwordx4 v[32:35], v3, s[16:19], s82 offen offset:1024 sc1
  buffer_load_dwordx4 v[36:39], v3, s[16:19], s82 offen offset:2048 sc1
  buffer_load_dwordx4 v[40:43], v3, s[16:19], s82 offen offset:3072 sc1
  buffer_load_dwordx4 v[44:47], v6, s[16:19], s83 offen sc1
  s_branch L_first_35
L_retry_32:
  s_sub_u32 s76, s76, 1
  s_cbranch_scc1 L_giveup_34
  s_mov_b64 exec, vcc
  buffer_load_dwordx4 v[28:31], v3, s[16:19], s82 offen offset:0 sc1
  buffer_load_dwordx4 v[32:35], v3, s[16:19], s82 offen offset:1024 sc1
  buffer_load_dwordx4 v[36:39], v3, s[16:19], s82 offen offset:2048 sc1
  buffer_load_dwordx4 v[40:43], v3, s[16:19], s82 offen offset:3072 sc1
  buffer_load_dwordx4 v[44:47], v6, s[16:19], s83 offen sc1
  s_mov_b64 exec, -1
L_first_35:
  s_waitcnt vmcnt(0)
L_chk_31:
  v_max3_u32 v56, v28, v29, v30
  v_max3_u32 v57, v39, v40, v41
  v_max3_u32 v56, v31, v32, v56
  v_max3_u32 v57, v42, v43, v57
  v_max3_u32 v56, v33, v34, v56
  v_max3_u32 v57, v44, v45, v57
  v_max3_u32 v56, v35, v36, v56
  v_max3_u32 v57, v46, v47, v57
  v_max3_u32 v56, v37, v38, v56
  v_max_u32 v56, v56, v57
  v_cmp_eq_u32 vcc, -1, v56
  s_cbranch_vccnz L_retry_32
L_got_33:
  v_mfma_f32_16x16x32_bf16 v[48:51], v[28:31], a[144:147], 0
  v_max3_f32 v60, v44, v45, v46
  v_max_f32 v60, v47, v60
  v_mov_b32 v61, v60
  v_mfma_f32_16x16x32_bf16 v[52:55], v[28:31], a[160:163], 0
  v_mfma_f32_16x16x32_bf16 v[48:51], v[32:35], a[148:151], v[48:51]
  v_permlane16_swap_b32 v60, v61
  v_max_f32 v60, v60, v61
  v_mov_b32 v61, v60
  v_mfma_f32_16x16x32_bf16 v[52:55], v[32:35], a[164:167], v[52:55]
  v_mfma_f32_16x16x32_bf16 v[48:51], v[36:39], a[152:155], v[48:51]
  v_permlane32_swap_b32 v60, v61
  v_max_f32 v60, v60, v61
  v_sub_f32 v56, v44, v60
  v_mfma_f32_16x16x32_bf16 v[52:55], v[36:39], a[168:171], v[52:55]
  v_sub_f32 v57, v45, v60
  v_sub_f32 v58, v46, v60
  v_mfma_f32_16x16x32_bf16 v[48:51], v[40:43], a[156:159], v[48:51]
  v_sub_f32 v59, v47, v60
  v_exp_f32 v56, v56
  v_mfma_f32_16x16x32_bf16 v[52:55], v[40:43], a[172:175], v[52:55]
  v_exp_f32 v57, v57
  v_exp_f32 v58, v58
  v_exp_f32 v59, v59
  v_add_f32 v60, v56, v57
  v_add_f32 v61, v58, v59
  v_add_f32 v60, v60, v61
  v_mov_b32 v61, v60
  v_mul_f32 v48, v56, v48
  v_mul_f32 v52, v56, v52
  v_permlane16_swap_b32 v60, v61
  v_fmac_f32 v48, v57, v49
  v_add_f32 v60, v60, v61
  v_fmac_f32 v52, v57, v53
  v_mov_b32 v61, v60
  v_fmac_f32 v48, v58, v50
  v_fmac_f32 v52, v58, v54
  v_permlane32_swap_b32 v60, v61
  v_fmac_f32 v48, v59, v51
  v_fmac_f32 v52, v59, v55
  v_add_f32 v60, v60, v61
  v_rcp_f32 v60, v60
  v_permlane16_swap_b32 v48, v52
  v_add_f32 v48, v48, v52
  v_mov_b32 v52, v48
  s_nop 1
  v_permlane32_swap_b32 v48, v52
  v_add_f32 v48, v48, v52
  s_mov_b32 exec_hi, 0
  v_mul_f32 v48, v48, v60
  buffer_store_dword v48, v1, s[16:19], s84 offen sc1
  s_mov_b64 exec, -1
  s_cmp_eq_u32 s6, 0
  s_cbranch_scc0 L_join_39
  buffer_load_dwordx4 v[240:243], v3, s[16:19], s95 offen offset:0 sc1
  buffer_load_dwordx4 v[244:247], v3, s[16:19], s95 offen offset:1024 sc1
  buffer_load_dwordx4 v[248:251], v3, s[16:19], s95 offen offset:2048 sc1
  buffer_load_dwordx4 v[252:255], v3, s[16:19], s95 offen offset:3072 sc1
  s_cmp_lt_u32 s5, 28
  s_cbranch_scc0 L_noffn_40
  s_mov_b32 s97, s42
  s_lshl_b32 s100, s3, 10
  s_add_u32 m0, s100, 32768
  s_nop 0
  buffer_load_dwordx4 v26, s[28:31], s42 offen nt lds
  s_lshl_b32 s100, s3, 10
  s_add_u32 m0, s100, 36864
  s_add_u32 s42, s42, 114688
  buffer_load_dwordx4 v26, s[28:31], s42 offen nt lds
  s_lshl_b32 s100, s3, 10
  s_add_u32 m0, s100, 40960
  s_nop 0
  buffer_load_dwordx4 v26, s[32:35], s97 offen nt lds
  s_lshl_b32 s100, s3, 10
  s_add_u32 m0, s100, 45056
  s_add_u32 s97, s97, 114688
  buffer_load_dwordx4 v26, s[32:35], s97 offen nt lds
  s_lshl_b32 s100, s3, 10
  s_add_u32 m0, s100, 49152
  s_nop 0
  buffer_load_dwordx4 v27, s[36:39], s43 offen nt lds
  s_lshl_b32 s100, s3, 10
  s_add_u32 m0, s100, 53248
  s_add_u32 s43, s43, 32768
  buffer_load_dwordx4 v27, s[36:39], s43 offen nt lds
  v_mov_b32 v224, -1
  v_mov_b32 v225, -1
  v_mov_b32 v226, -1
  v_mov_b32 v227, -1
  buffer_store_dwordx4 v[224:227], v0, s[16:19], s40 offen sc1
  v_lshlrev_b32 v26, 3, v0
  s_mov_b32 exec_hi, 0
  s_bfe_u32 s96, s2, 0x50003
  s_lshl_b32 s96, s96, 10
  s_add_u32 s96, s96, s4
  s_add_u32 s96, s96, 0x20000
  s_mov_b32 exec_lo, 0xf
  s_cmp_eq_u32 s3, 0
  s_cbranch_scc1 L_pt_42
  s_bfe_u32 s96, s2, 0x50003
  s_lshl_b32 s96, s96, 10
  s_add_u32 s96, s96, s4
  s_add_u32 s96, s96, 0x20200
  s_mov_b32 exec_lo, 0xf
  s_cmp_eq_u32 s3, 1
  s_cbranch_scc1 L_pt_42
  s_bfe_u32 s96, s2, 0x40003
  s_lshl_b32 s96, s96, 9
  s_bfe_u32 s100, s2, 0x10007
  s_lshl_b32 s100, s100, 17
  s_add_u32 s96, s96, s100
  s_add_u32 s96, s96, s4
  s_add_u32 s96, s96, 0x8000
  s_mov_b32 exec_lo, 0xf
  s_cmp_eq_u32 s3, 2
  s_cbranch_scc1 L_pt_42
  s_bfe_u32 s96, s2, 0x50003
  s_lshl_b32 s96, s96, 7
  s_add_u32 s96, s96, s4
  s_add_u32 s96, s96, 0xb000
  s_mov_b32 exec_lo, 0x1
L_pt_42:
  buffer_load_dword a204, v26, s[16:19], s96 offen sc1
  s_mov_b64 exec, -1
  s_waitcnt vmcnt(8)
L_ffnj_41:
  s_branch L_chk_43
L_retry_44:
  s_sub_u32 s76, s76, 1
  s_cbranch_scc1 L_giveup_46
  s_mov_b64 exec, vcc
  buffer_load_dwordx4 v[240:243], v3, s[16:19], s95 offen offset:0 sc1
  buffer_load_dwordx4 v[244:247], v3, s[16:19], s95 offen offset:1024 sc1
  buffer_load_dwordx4 v[248:251], v3, s[16:19], s95 offen offset:2048 sc1
  buffer_load_dwordx4 v[252:255], v3, s[16:19], s95 offen offset:3072 sc1
  s_mov_b64 exec, -1
L_first_47:
  s_waitcnt vmcnt(0)
L_chk_43:
  v_max3_u32 v76, v240, v241, v242
  v_max3_u32 v77, v249, v250, v251
  v_max3_u32 v76, v243, v244, v76
  v_max3_u32 v77, v252, v253, v77
  v_max3_u32 v76, v245, v246, v76
  v_max3_u32 v77, v254, v255, v77
  v_max3_u32 v76, v247, v248, v76
  v_max_u32 v76, v76, v77
  v_cmp_eq_u32 vcc, -1, v76
  s_cbranch_vccnz L_retry_44
L_got_45:
  s_barrier
  buffer_load_dwordx4 v[28:31], v0, s[16:19], s85 offen offset:0 sc1
  buffer_load_dwordx4 v[32:35], v0, s[16:19], s85 offen offset:1024 sc1
  buffer_load_dwordx4 v[36:39], v0, s[16:19], s85 offen offset:2048 sc1
  buffer_load_dwordx4 v[40:43], v0, s[16:19], s85 offen offset:3072 sc1
  v_mfma_f32_16x16x32_bf16 v[44:47], a[0:3], v[240:243], 0
  v_mfma_f32_16x16x32_bf16 v[44:47], a[4:7], v[244:247], v[44:47]
  v_mfma_f32_16x16x32_bf16 v[44:47], a[8:11], v[248:251], v[44:47]
  v_mfma_f32_16x16x32_bf16 v[44:47], a[12:15], v[252:255], v[44:47]
  v_mfma_f32_16x16x32_bf16 v[52:55], a[32:35], v[240:243], 0
  v_mfma_f32_16x16x32_bf16 v[52:55], a[36:39], v[244:247], v[52:55]
  v_mfma_f32_16x16x32_bf16 v[52:55], a[40:43], v[248:251], v[52:55]
  v_mfma_f32_16x16x32_bf16 v[52:55], a[44:47], v[252:255], v[52:55]
  v_mfma_f32_16x16x32_bf16 v[48:51], a[16:19], v[240:243], 0
  v_mfma_f32_16x16x32_bf16 v[48:51], a[20:23], v[244:247], v[48:51]
  v_mfma_f32_16x16x32_bf16 v[48:51], a[24:27], v[248:251], v[48:51]
  v_mfma_f32_16x16x32_bf16 v[48:51], a[28:31], v[252:255], v[48:51]
  v_add_f32_dpp v80, v44, v44 row_ror:8 row_mask:0xf bank_mask:0x3
  v_add_f32_dpp v81, v45, v45 row_ror:8 row_mask:0xf bank_mask:0x3
  v_mfma_f32_16x16x32_bf16 v[56:59], a[48:51], v[240:243], 0
  v_add_f32_dpp v82, v46, v46 row_ror:8 row_mask:0xf bank_mask:0x3
  v_add_f32_dpp v83, v47, v47 row_ror:8 row_mask:0xf bank_mask:0x3
  v_mfma_f32_16x16x32_bf16 v[56:59], a[52:55], v[244:247], v[56:59]
  v_add_f32_dpp v80, v52, v52 row_ror:8 row_mask:0xf bank_mask:0xc
  v_add_f32_dpp v81, v53, v53 row_ror:8 row_mask:0xf bank_mask:0xc
  v_mfma_f32_16x16x32_bf16 v[56:59], a[56:59], v[248:251], v[56:59]
  v_add_f32_dpp v82, v54, v54 row_ror:8 row_mask:0xf bank_mask:0xc
  v_add_f32_dpp v83, v55, v55 row_ror:8 row_mask:0xf bank_mask:0xc
  v_mfma_f32_16x16x32_bf16 v[56:59], a[60:63], v[252:255], v[56:59]
  v_add_f32_dpp v232, v80, v80 row_ror:12 row_mask:0xf bank_mask:0x5
  v_add_f32_dpp v233, v81, v81 row_ror:12 row_mask:0xf bank_mask:0x5
  v_mfma_f32_16x16x32_bf16 v[60:63], a[64:67], v[240:243], 0
  v_add_f32_dpp v234, v82, v82 row_ror:12 row_mask:0xf bank_mask:0x5
  v_add_f32_dpp v235, v83, v83 row_ror:12 row_mask:0xf bank_mask:0x5
  v_mfma_f32_16x16x32_bf16 v[60:63], a[68:71], v[244:247], v[60:63]
  v_add_f32_dpp v84, v48, v48 row_ror:8 row_mask:0xf bank_mask:0x3
  v_add_f32_dpp v85, v49, v49 row_ror:8 row_mask:0xf bank_mask:0x3
  v_mfma_f32_16x16x32_bf16 v[60:63], a[72:75], v[248:251], v[60:63]
  v_add_f32_dpp v86, v50, v50 row_ror:8 row_mask:0xf bank_mask:0x3
  v_add_f32_dpp v87, v51, v51 row_ror:8 row_mask:0xf bank_mask:0x3
  v_mfma_f32_16x16x32_bf16 v[60:63], a[76:79], v[252:255], v[60:63]
  v_add_f32_dpp v84, v56, v56 row_ror:8 row_mask:0xf bank_mask:0xc
  v_add_f32_dpp v85, v57, v57 row_ror:8 row_mask:0xf bank_mask:0xc
  v_mfma_f32_16x16x32_bf16 v[68:71], a[96:99], v[240:243], 0
  v_add_f32_dpp v86, v58, v58 row_ror:8 row_mask:0xf bank_mask:0xc
  v_add_f32_dpp v87, v59, v59 row_ror:8 row_mask:0xf bank_mask:0xc
  v_mfma_f32_16x16x32_bf16 v[68:71], a[100:103], v[244:247], v[68:71]
  v_add_f32_dpp v232, v84, v84 row_ror:4 row_mask:0xf bank_mask:0xa
  v_add_f32_dpp v233, v85, v85 row_ror:4 row_mask:0xf bank_mask:0xa
  v_mfma_f32_16x16x32_bf16 v[68:71], a[104:107], v[248:251], v[68:71]
  v_add_f32_dpp v234, v86, v86 row_ror:4 row_mask:0xf bank_mask:0xa
  v_add_f32_dpp v235, v87, v87 row_ror:4 row_mask:0xf bank_mask:0xa
  v_mfma_f32_16x16x32_bf16 v[68:71], a[108:111], v[252:255], v[68:71]
  s_nop 0
  s_nop 0
  v_mfma_f32_16x16x32_bf16 v[64:67], a[80:83], v[240:243], 0
  v_add_f32_dpp v80, v60, v60 row_ror:8 row_mask:0xf bank_mask:0x3
  v_add_f32_dpp v81, v61, v61 row_ror:8 row_mask:0xf bank_mask:0x3
  v_mfma_f32_16x16x32_bf16 v[64:67], a[84:87], v[244:247], v[64:67]
  v_add_f32_dpp v82, v62, v62 row_ror:8 row_mask:0xf bank_mask:0x3
  v_add_f32_dpp v83, v63, v63 row_ror:8 row_mask:0xf bank_mask:0x3
  v_mfma_f32_16x16x32_bf16 v[64:67], a[88:91], v[248:251], v[64:67]
  v_add_f32_dpp v80, v68, v68 row_ror:8 row_mask:0xf bank_mask:0xc
  v_add_f32_dpp v81, v69, v69 row_ror:8 row_mask:0xf bank_mask:0xc
  v_mfma_f32_16x16x32_bf16 v[64:67], a[92:95], v[252:255], v[64:67]
  v_add_f32_dpp v82, v70, v70 row_ror:8 row_mask:0xf bank_mask:0xc
  v_add_f32_dpp v83, v71, v71 row_ror:8 row_mask:0xf bank_mask:0xc
  v_mfma_f32_16x16x32_bf16 v[72:75], a[112:115], v[240:243], 0
  v_add_f32_dpp v236, v80, v80 row_ror:12 row_mask:0xf bank_mask:0x5
  v_add_f32_dpp v237, v81, v81 row_ror:12 row_mask:0xf bank_mask:0x5
  v_mfma_f32_16x16x32_bf16 v[72:75], a[116:119], v[244:247], v[72:75]
  v_add_f32_dpp v238, v82, v82 row_ror:12 row_mask:0xf bank_mask:0x5
  v_add_f32_dpp v239, v83, v83 row_ror:12 row_mask:0xf bank_mask:0x5
  v_mfma_f32_16x16x32_bf16 v[72:75], a[120:123], v[248:251], v[72:75]
  v_add_f32_dpp v84, v64, v64 row_ror:8 row_mask:0xf bank_mask:0x3
  v_add_f32_dpp v85, v65, v65 row_ror:8 row_mask:0xf bank_mask:0x3
  v_mfma_f32_16x16x32_bf16 v[72:75], a[124:127], v[252:255], v[72:75]
  v_add_f32_dpp v86, v66, v66 row_ror:8 row_mask:0xf bank_mask:0x3
  v_add_f32_dpp v87, v67, v67 row_ror:8 row_mask:0xf bank_mask:0x3
  s_nop 5
  v_add_f32_dpp v84, v72, v72 row_ror:8 row_mask:0xf bank_mask:0xc
  v_add_f32_dpp v85, v73, v73 row_ror:8 row_mask:0xf bank_mask:0xc
  v_add_f32_dpp v86, v74, v74 row_ror:8 row_mask:0xf bank_mask:0xc
  v_add_f32_dpp v87, v75, v75 row_ror:8 row_mask:0xf bank_mask:0xc
  v_add_f32_dpp v236, v84, v84 row_ror:4 row_mask:0xf bank_mask:0xa
  v_add_f32_dpp v237, v85, v85 row_ror:4 row_mask:0xf bank_mask:0xa
  v_add_f32_dpp v238, v86, v86 row_ror:4 row_mask:0xf bank_mask:0xa
  v_add_f32_dpp v239, v87, v87 row_ror:4 row_mask:0xf bank_mask:0xa
  s_branch L_m1wait
L_join_39:
  s_add_u32 s96, s87, s4
  s_add_u32 s96, s96, 0xb400
  buffer_load_dword v48, v10, s[16:19], s96 offen sc1
  s_branch L_first_52
L_retry_49:
  s_sub_u32 s76, s76, 1
  s_cbranch_scc1 L_giveup_51
  s_mov_b64 exec, vcc
  buffer_load_dword v48, v10, s[16:19], s96 offen sc1
  s_mov_b64 exec, -1
L_first_52:
  s_waitcnt vmcnt(0)
L_chk_48:
  v_mov_b32 v49, v48
  v_cmp_eq_u32 vcc, -1, v49
  s_cbranch_vccnz L_retry_49
L_got_50:
  v_lshlrev_b32 v21, 16, v48
  v_and_b32 v22, 0xffff0000, v48
L_acked:
  s_barrier
  buffer_load_dwordx4 v[28:31], v0, s[16:19], s85 offen offset:0 sc1
  buffer_load_dwordx4 v[32:35], v0, s[16:19], s85 offen offset:1024 sc1
  buffer_load_dwordx4 v[36:39], v0, s[16:19], s85 offen offset:2048 sc1
  buffer_load_dwordx4 v[40:43], v0, s[16:19], s85 offen offset:3072 sc1
  s_branch L_m1wait
L_retry_54:
  s_sub_u32 s76, s76, 1
  s_cbranch_scc1 L_giveup_56
  s_mov_b64 exec, vcc
  buffer_load_dwordx4 v[28:31], v0, s[16:19], s85 offen offset:0 sc1
  buffer_load_dwordx4 v[32:35], v0, s[16:19], s85 offen offset:1024 sc1
  buffer_load_dwordx4 v[36:39], v0, s[16:19], s85 offen offset:2048 sc1
  buffer_load_dwordx4 v[40:43], v0, s[16:19], s85 offen offset:3072 sc1
  s_mov_b64 exec, -1
L_m1wait:
  s_waitcnt vmcnt(0)
L_chk_53:
  v_max3_u32 v44, v28, v29, v30
  v_max3_u32 v45, v37, v38, v39
  v_max3_u32 v44, v31, v32, v44
  v_max3_u32 v45, v40, v41, v45
  v_max3_u32 v44, v33, v34, v44
  v_max3_u32 v45, v42, v43, v45
  v_max3_u32 v44, v35, v36, v44
  v_max_u32 v44, v44, v45
  v_cmp_eq_u32 vcc, -1, v44
  s_cbranch_vccnz L_retry_54
L_got_55:
  v_pk_add_f32 v[28:29], v[28:29], v[32:33]
  v_pk_add_f32 v[30:31], v[30:31], v[34:35]
  v_pk_add_f32 v[36:37], v[36:37], v[40:41]
  v_pk_add_f32 v[38:39], v[38:39], v[42:43]
  v_pk_add_f32 v[28:29], v[28:29], v[36:37]
  v_pk_add_f32 v[30:31], v[30:31], v[38:39]
  s_nop 1
  v_permlane32_swap_b32 v28, v30
  v_permlane32_swap_b32 v29, v31
  v_add_f32 v28, v28, v30
  v_add_f32 v29, v29, v31
  s_nop 0
  v_add_f32_dpp v28, v28, v28 row_ror:8 row_mask:0xf bank_mask:0xf
  v_add_f32_dpp v29, v29, v29 row_ror:8 row_mask:0xf bank_mask:0xf
  v_mov_b32 v30, v28
  v_mov_b32 v31, v29
  s_nop 0
  v_permlane16_swap_b32 v28, v30
  v_permlane16_swap_b32 v29, v31
  v_add_f32 v21, v21, v28
  v_add_f32 v22, v22, v29
  v_add_f32 v21, v21, v30
  v_add_f32 v22, v22, v31
  v_cvt_pk_bf16_f32 v28, v21, v22
  ds_write_b32 v20, v28
  v_lshlrev_b32 v21, 16, v28
  v_and_b32 v22, 0xffff0000, v28
  v_add_f32 v29, v21, v22
  v_mul_f32 v30, v21, v21
  v_fmac_f32 v30, v22, v22
  s_waitcnt lgkmcnt(0)
  s_barrier
  s_cmp_lt_u32 s5, 28
  s_cbranch_scc0 L_stageD
  ds_read_b128 v[32:35], v18 offset:256
  ds_read_b128 v[36:39], v18 offset:320
  s_cmp_eq_u32 s6, 0
  s_cbranch_scc0 L_join_59
  ds_read_b64_tr_b16 a[176:177], v17 offset:32768
  ds_read_b64_tr_b16 a[178:179], v17 offset:33280
  ds_read_b64_tr_b16 a[180:181], v17 offset:36864
  ds_read_b64_tr_b16 a[182:183], v17 offset:37376
  ds_read_b64_tr_b16 a[184:185], v17 offset:40960
  ds_read_b64_tr_b16 a[186:187], v17 offset:41472
  ds_read_b64_tr_b16 a[188:189], v17 offset:45056
  ds_read_b64_tr_b16 a[190:191], v17 offset:45568
L_join_59:
  v_permlane32_swap_b32 v29, v30
  v_add_f32 v29, v29, v30
  s_nop 1
  v_add_f32_dpp v29, v29, v29 quad_perm:[1,0,3,2] row_mask:0xf bank_mask:0xf
  s_waitcnt lgkmcnt(0)
  v_mfma_f32_16x16x32_bf16 v[40:43], v[32:35], a[176:179], 0
  v_add_f32_dpp v29, v29, v29 quad_perm:[2,3,0,1] row_mask:0xf bank_mask:0xf
  v_mfma_f32_16x16x32_bf16 v[44:47], v[32:35], a[184:187], 0
  s_nop 0
  v_add_f32_dpp v29, v29, v29 row_ror:4 row_mask:0xf bank_mask:0xf
  v_mfma_f32_16x16x32_bf16 v[40:43], v[36:39], a[180:183], v[40:43]
  v_mfma_f32_16x16x32_bf16 v[44:47], v[36:39], a[188:191], v[44:47]
  s_mov_b32 exec_lo, 1
  s_mov_b32 exec_hi, 1
  s_cmp_eq_u32 s7, 1
  s_cbranch_scc0 L_wt_60
  buffer_store_dword v29, v10, s[16:19], s88 offen
L_back_61:
  s_mov_b64 exec, 0xffff
  s_nop 1
  v_mov_b32 v47, v42
  v_mov_b32 v42, v44
  v_mov_b32 v43, v45
  s_cmp_eq_u32 s7, 1
  s_cbranch_scc0 L_wt_62
  buffer_store_dwordx4 v[40:43], v5, s[16:19], s91 offen
L_back_63:
  s_mov_b64 exec, -1
  s_cmp_eq_u32 s6, 0
  s_cbranch_scc0 L_join_65
  v_lshrrev_b32 v60, 1, v5
  s_mov_b64 exec, 0xffff
  s_cmp_eq_u32 s7, 1
  s_cbranch_scc0 L_wt_66
  buffer_store_dwordx2 v[46:47], v60, s[16:19], s94 offen
L_back_67:
  s_mov_b64 exec, -1
  ds_read_b64_tr_b16 a[192:193], v17 offset:49152
  ds_read_b64_tr_b16 a[194:195], v17 offset:49664
  ds_read_b64_tr_b16 a[196:197], v17 offset:53248
  ds_read_b64_tr_b16 a[198:199], v17 offset:53760
  s_cmp_lt_u32 s5, 8
  s_cbranch_scc0 L_join_65
  s_add_u32 s96, s87, s4
  s_add_u32 s96, s96, 0xb400
  s_mov_b32 exec_lo, 0xff
  s_mov_b32 exec_hi, 0xff
  s_cmp_eq_u32 s7, 1
  s_cbranch_scc0 L_wt_68
  buffer_store_dword v28, v10, s[16:19], s96 offen
L_back_69:
  s_mov_b64 exec, -1
L_join_65:
L_stageD:
  s_cmp_eq_u32 s6, 0
  s_cbranch_scc0 L_join_71
  v_lshrrev_b32 v48, 1, v9
  buffer_load_dwordx4 v[28:31], v9, s[16:19], s92 offen offset:0 sc1
  buffer_load_dwordx4 v[32:35], v9, s[16:19], s92 offen offset:1024 sc1
  buffer_load_dwordx2 v[36:37], v19, s[16:19], s90 offen sc1
  buffer_load_dwordx2 v[44:45], v48, s[16:19], s41 offen offset:0 sc1
  buffer_load_dwordx2 v[46:47], v48, s[16:19], s41 offen offset:512 sc1
  s_branch L_first_76
L_retry_73:
  s_sub_u32 s76, s76, 1
  s_cbranch_scc1 L_giveup_75
  s_mov_b64 exec, vcc
  buffer_load_dwordx4 v[28:31], v9, s[16:19], s92 offen offset:0 sc1
  buffer_load_dwordx4 v[32:35], v9, s[16:19], s92 offen offset:1024 sc1
  buffer_load_dwordx2 v[36:37], v19, s[16:19], s90 offen sc1
  buffer_load_dwordx2 v[44:45], v48, s[16:19], s41 offen offset:0 sc1
  buffer_load_dwordx2 v[46:47], v48, s[16:19], s41 offen offset:512 sc1
  s_mov_b64 exec, -1
L_first_76:
  s_waitcnt vmcnt(0)
L_chk_72:
  v_max3_u32 v40, v28, v29, v30
  v_max3_u32 v41, v35, v36, v37
  v_max3_u32 v40, v31, v32, v40
  v_max3_u32 v41, v44, v45, v41
  v_max3_u32 v40, v33, v34, v40
  v_max3_u32 v41, v46, v47, v41
  v_max_u32 v40, v40, v41
  v_cmp_eq_u32 vcc, -1, v40
  s_cbranch_vccnz L_retry_73
L_got_74:
  v_add_f32 v44, v44, v46
  v_add_f32 v45, v45, v47
  s_nop 1
  v_permlane16_swap_b32 v45, v44
  v_add_f32 v23, v44, v45
  v_mov_b32 v44, v23
  s_nop 1
  v_permlane32_swap_b32 v23, v44
  v_add_f32 v23, v23, v44
  s_branch L_dgot
L_join_71:
  s_waitcnt vmcnt(0)
  buffer_load_dwordx4 v[28:31], v9, s[16:19], s92 offen offset:0 sc1
  buffer_load_dwordx4 v[32:35], v9, s[16:19], s92 offen offset:1024 sc1
  buffer_load_dwordx2 v[36:37], v19, s[16:19], s90 offen sc1
  s_branch L_first_81
L_retry_78:
  s_sub_u32 s76, s76, 1
  s_cbranch_scc1 L_giveup_80
  s_mov_b64 exec, vcc
  buffer_load_dwordx4 v[28:31], v9, s[16:19], s92 offen offset:0 sc1
  buffer_load_dwordx4 v[32:35], v9, s[16:19], s92 offen offset:1024 sc1
  buffer_load_dwordx2 v[36:37], v19, s[16:19], s90 offen sc1
  s_mov_b64 exec, -1
L_first_81:
  s_waitcnt vmcnt(0)
L_chk_77:
  v_max3_u32 v40, v28, v29, v30
  v_max3_u32 v41, v33, v34, v35
  v_max3_u32 v40, v31, v32, v40
  v_max3_u32 v41, v36, v37, v41
  v_max_u32 v40, v40, v41
  v_cmp_eq_u32 vcc, -1, v40
  s_cbranch_vccnz L_retry_78
L_dgot:
  v_add_f32_dpp v36, v36, v36 row_ror:1 row_mask:0xf bank_mask:0xf
  v_add_f32_dpp v37, v37, v37 row_ror:1 row_mask:0xf bank_mask:0xf
  v_add_f32 v28, v28, v32
  v_add_f32_dpp v36, v36, v36 row_ror:2 row_mask:0xf bank_mask:0xf
  v_add_f32_dpp v37, v37, v37 row_ror:2 row_mask:0xf bank_mask:0xf
  v_add_f32 v29, v29, v33
  v_add_f32_dpp v36, v36, v36 row_ror:4 row_mask:0xf bank_mask:0xf
  v_add_f32_dpp v37, v37, v37 row_ror:4 row_mask:0xf bank_mask:0xf
  v_add_f32 v30, v30, v34
  v_add_f32_dpp v36, v36, v36 row_ror:8 row_mask:0xf bank_mask:0xf
  v_add_f32_dpp v37, v37, v37 row_ror:8 row_mask:0xf bank_mask:0xf
  v_add_f32 v31, v31, v35
  v_mul_f32 v36, 0xbb000000, v36
  v_mul_f32 v37, 0x3b000000, v37
  v_permlane32_swap_b32 v28, v29
  v_fma_f32 v37, -v36, v36, v37
  v_permlane32_swap_b32 v30, v31
  v_max_f32 v37, 0, v37
  v_add_f32 v28, v28, v29
  v_add_f32 v30, v30, v31
  v_add_f32 v37, 0x3727c5ac, v37
  v_rsq_f32 v37, v37
  v_permlane16_swap_b32 v28, v30
  v_add_f32 v28, v28, v30
  v_fmac_f32 v28, v36, v23
  v_mul_f32 v28, v28, v37
  v_mov_b32 v29, v28
  s_nop 1
  v_permlane16_swap_b32 v28, v29
  v_max_f32 v28, 0, v28
  v_mul_f32 v28, v28, v29
  v_cvt_pk_bf16_f32 v28, v28, v28
  ds_write_b16 v15, v28
  s_waitcnt lgkmcnt(0)
  s_barrier
  ds_read_b128 v[44:47], v16
  ds_read_b128 v[48:51], v16 offset:64
  s_waitcnt lgkmcnt(1)
  v_mfma_f32_16x16x32_bf16 v[40:43], a[192:195], v[44:47], 0
  s_waitcnt lgkmcnt(0)
  v_mfma_f32_16x16x32_bf16 v[40:43], a[196:199], v[48:51], v[40:43]
  s_bfe_u32 s96, s2, 0x20006
  s_and_b32 s97, s2, 7
  s_mov_b32 exec_lo, 0x30003
  s_mov_b32 exec_hi, 0x30003
  s_nop 3
  buffer_store_dwordx4 v[40:43], v8, s[16:19], s93 offen sc1
  s_mov_b64 exec, -1
  s_cmp_eq_u32 s6, 0
  s_cbranch_scc1 L_next
  s_cmp_eq_u32 s97, 0
  s_cbranch_scc0 L_fin
  s_waitcnt vmcnt(0)
  s_barrier
  s_cmp_eq_u32 s96, s3
  s_cbranch_scc0 L_fin
  buffer_load_dwordx4 v[28:31], v0, s[16:19], s86 offen offset:0 sc1
  buffer_load_dwordx4 v[32:35], v0, s[16:19], s86 offen offset:1024 sc1
  buffer_load_dwordx4 v[36:39], v0, s[16:19], s86 offen offset:2048 sc1
  buffer_load_dwordx4 v[40:43], v0, s[16:19], s86 offen offset:3072 sc1
  s_branch L_first_86
L_retry_83:
  s_sub_u32 s76, s76, 1
  s_cbranch_scc1 L_giveup_85
  s_mov_b64 exec, vcc
  buffer_load_dwordx4 v[28:31], v0, s[16:19], s86 offen offset:0 sc1
  buffer_load_dwordx4 v[32:35], v0, s[16:19], s86 offen offset:1024 sc1
  buffer_load_dwordx4 v[36:39], v0, s[16:19], s86 offen offset:2048 sc1
  buffer_load_dwordx4 v[40:43], v0, s[16:19], s86 offen offset:3072 sc1
  s_mov_b64 exec, -1
L_first_86:
  s_waitcnt vmcnt(0)
L_chk_82:
  v_max3_u32 v44, v28, v29, v30
  v_max3_u32 v45, v37, v38, v39
  v_max3_u32 v44, v31, v32, v44
  v_max3_u32 v45, v40, v41, v45
  v_max3_u32 v44, v33, v34, v44
  v_max3_u32 v45, v42, v43, v45
  v_max3_u32 v44, v35, v36, v44
  v_max_u32 v44, v44, v45
  v_cmp_eq_u32 vcc, -1, v44
  s_cbranch_vccnz L_retry_83
L_got_84:
  v_pk_add_f32 v[28:29], v[28:29], v[32:33]
  v_pk_add_f32 v[30:31], v[30:31], v[34:35]
  v_pk_add_f32 v[36:37], v[36:37], v[40:41]
  v_pk_add_f32 v[38:39], v[38:39], v[42:43]
  v_pk_add_f32 v[28:29], v[28:29], v[36:37]
  v_pk_add_f32 v[30:31], v[30:31], v[38:39]
  s_nop 1
  v_permlane32_swap_b32 v28, v30
  v_permlane32_swap_b32 v29, v31
  v_add_f32 v28, v28, v30
  v_add_f32 v29, v29, v31
  s_nop 0
  v_add_f32_dpp v28, v28, v28 row_ror:8 row_mask:0xf bank_mask:0xf
  v_add_f32_dpp v29, v29, v29 row_ror:8 row_mask:0xf bank_mask:0xf
  v_mov_b32 v30, v28
  v_mov_b32 v31, v29
  s_nop 0
  v_permlane16_swap_b32 v28, v30
  v_permlane16_swap_b32 v29, v31
  v_add_f32 v21, v21, v28
  v_add_f32 v22, v22, v29
  v_add_f32 v21, v21, v30
  v_add_f32 v22, v22, v31
  v_cvt_pk_bf16_f32 v28, v21, v22
  s_mov_b32 exec_lo, 0xff
  s_mov_b32 exec_hi, 0xff
  buffer_store_dword v28, v10, s[44:47], s87 offen
  s_endpgm
L_next:
  v_lshlrev_b32 v68, 3, v0
  s_mov_b32 exec_hi, 0
  s_bfe_u32 s96, s2, 0x50003
  s_lshl_b32 s96, s96, 10
  s_add_u32 s96, s96, s4
  s_add_u32 s96, s96, 0x10000
  s_mov_b32 exec_lo, 0xff
  s_cmp_eq_u32 s3, 0
  s_cbranch_scc1 L_pt_87
  s_bfe_u32 s96, s2, 0x50003
  s_lshl_b32 s96, s96, 10
  s_add_u32 s96, s96, s4
  s_add_u32 s96, s96, 0x30000
  s_mov_b32 exec_lo, 0xff
  s_cmp_eq_u32 s3, 1
  s_cbranch_scc1 L_pt_87
  s_bfe_u32 s96, s2, 0x40003
  s_lshl_b32 s96, s96, 8
  s_bfe_u32 s100, s2, 0x10007
  s_lshl_b32 s100, s100, 17
  s_add_u32 s96, s96, s100
  s_add_u32 s96, s96, s4
  s_add_u32 s96, s96, 0x1a000
  s_mov_b32 exec_lo, 0x3
  s_cmp_eq_u32 s3, 2
  s_cbranch_scc1 L_pt_87
  s_bfe_u32 s96, s2, 0x50003
  s_lshl_b32 s96, s96, 7
  s_add_u32 s96, s96, s4
  s_add_u32 s96, s96, 0x1b000
  s_mov_b32 exec_lo, 0x1
L_pt_87:
  buffer_load_dword a204, v68, s[16:19], s96 offen sc1
  s_mov_b64 exec, -1
  s_bfe_u32 s96, s3, 0x10001
  s_lshl_b32 s96, s96, 19
  s_bfe_u32 s100, s2, 0x20006
  s_lshl_b32 s100, s100, 17
  s_add_u32 s96, s96, s100
  s_bfe_u32 s100, s3, 0x10000
  s_lshl_b32 s100, s100, 13
  s_add_u32 s96, s96, s100
  s_add_u32 s96, s96, 0x10c000
  s_add_u32 s97, s96, 4096
  s_bfe_u32 s95, s3, 0x10001
  s_lshl_b32 s95, s95, 10
  s_bfe_u32 s100, s2, 0x20006
  s_lshl_b32 s100, s100, 8
  s_add_u32 s95, s95, s100
  s_bfe_u32 s100, s3, 0x10000
  s_lshl_b32 s100, s100, 7
  s_add_u32 s95, s95, s100
  s_add_u32 s95, s95, s4
  s_add_u32 s95, s95, 0xb400
  s_lshl_b32 s94, s3, 7
  s_add_u32 s94, s94, 0x10380
  v_add_u32 v68, s94, v10
  v_and_b32 v69, 16, v0
  v_lshl_add_u32 v69, v69, 4, v6
  v_add_u32 v69, 66432, v69
  s_bfe_u32 s94, s2, 0x20006
  s_lshl_b32 s94, s94, 5
  s_bfe_u32 s100, s3, 0x10000
  s_lshl_b32 s100, s100, 4
  s_add_u32 s94, s94, s100
  s_bfe_u32 s100, s3, 0x10001
  s_lshl_b32 s100, s100, 3
  s_add_u32 s94, s94, s100
  s_add_u32 s94, s94, s4
  s_add_u32 s94, s94, 0xbc00
  buffer_load_dword v60, v10, s[16:19], s95 offen sc1
  buffer_load_dword v61, v10, s[16:19], s95 offen offset:64 sc1
  s_branch L_first_92
L_retry_89:
  s_sub_u32 s76, s76, 1
  s_cbranch_scc1 L_giveup_91
  s_mov_b64 exec, vcc
  buffer_load_dword v60, v10, s[16:19], s95 offen sc1
  buffer_load_dword v61, v10, s[16:19], s95 offen offset:64 sc1
  s_mov_b64 exec, -1
L_first_92:
  s_waitcnt vmcnt(0)
L_chk_88:
  v_max_u32 v64, v60, v61
  v_cmp_eq_u32 vcc, -1, v64
  s_cbranch_vccnz L_retry_89
L_got_90:
  v_lshlrev_b32 v62, 16, v61
  v_and_b32 v63, 0xffff0000, v61
  v_and_b32 v61, 0xffff0000, v60
  v_lshlrev_b32 v60, 16, v60
  s_barrier
  buffer_load_dwordx4 v[28:31], v0, s[16:19], s96 offen offset:0 sc1
  buffer_load_dwordx4 v[32:35], v0, s[16:19], s96 offen offset:1024 sc1
  buffer_load_dwordx4 v[36:39], v0, s[16:19], s96 offen offset:2048 sc1
  buffer_load_dwordx4 v[40:43], v0, s[16:19], s96 offen offset:3072 sc1
  buffer_load_dwordx4 v[44:47], v0, s[16:19], s97 offen offset:0 sc1
  buffer_load_dwordx4 v[48:51], v0, s[16:19], s97 offen offset:1024 sc1
  buffer_load_dwordx4 v[52:55], v0, s[16:19], s97 offen offset:2048 sc1
  buffer_load_dwordx4 v[56:59], v0, s[16:19], s97 offen offset:3072 sc1
  s_branch L_first_97
L_retry_94:
  s_sub_u32 s76, s76, 1
  s_cbranch_scc1 L_giveup_96
  s_mov_b64 exec, vcc
  buffer_load_dwordx4 v[28:31], v0, s[16:19], s96 offen offset:0 sc1
  buffer_load_dwordx4 v[32:35], v0, s[16:19], s96 offen offset:1024 sc1
  buffer_load_dwordx4 v[36:39], v0, s[16:19], s96 offen offset:2048 sc1
  buffer_load_dwordx4 v[40:43], v0, s[16:19], s96 offen offset:3072 sc1
  buffer_load_dwordx4 v[44:47], v0, s[16:19], s97 offen offset:0 sc1
  buffer_load_dwordx4 v[48:51], v0, s[16:19], s97 offen offset:1024 sc1
  buffer_load_dwordx4 v[52:55], v0, s[16:19], s97 offen offset:2048 sc1
  buffer_load_dwordx4 v[56:59], v0, s[16:19], s97 offen offset:3072 sc1
  s_mov_b64 exec, -1
L_first_97:
  s_waitcnt vmcnt(0)
L_chk_93:
  v_max3_u32 v64, v28, v29, v30
  v_max3_u32 v65, v45, v46, v47
  v_max3_u32 v64, v31, v32, v64
  v_max3_u32 v65, v48, v49, v65
  v_max3_u32 v64, v33, v34, v64
  v_max3_u32 v65, v50, v51, v65
  v_max3_u32 v64, v35, v36, v64
  v_max3_u32 v65, v52, v53, v65
  v_max3_u32 v64, v37, v38, v64
  v_max3_u32 v65, v54, v55, v65
  v_max3_u32 v64, v39, v40, v64
  v_max3_u32 v65, v56, v57, v65
  v_max3_u32 v64, v41, v42, v64
  v_max3_u32 v65, v58, v59, v65
  v_max3_u32 v64, v43, v44, v64
  v_max_u32 v64, v64, v65
  v_cmp_eq_u32 vcc, -1, v64
  s_cbranch_vccnz L_retry_94
L_got_95:
  v_pk_add_f32 v[28:29], v[28:29], v[32:33]
  v_pk_add_f32 v[30:31], v[30:31], v[34:35]
  v_pk_add_f32 v[36:37], v[36:37], v[40:41]
  v_pk_add_f32 v[38:39], v[38:39], v[42:43]
  v_pk_add_f32 v[28:29], v[28:29], v[36:37]
  v_pk_add_f32 v[30:31], v[30:31], v[38:39]
  v_pk_add_f32 v[44:45], v[44:45], v[48:49]
  v_pk_add_f32 v[46:47], v[46:47], v[50:51]
  v_pk_add_f32 v[52:53], v[52:53], v[56:57]
  v_pk_add_f32 v[54:55], v[54:55], v[58:59]
  v_pk_add_f32 v[44:45], v[44:45], v[52:53]
  v_pk_add_f32 v[46:47], v[46:47], v[54:55]
  v_permlane32_swap_b32 v28, v30
  v_permlane32_swap_b32 v29, v31
  v_permlane32_swap_b32 v44, v46
  v_permlane32_swap_b32 v45, v47
  v_add_f32 v28, v28, v30
  v_add_f32 v29, v29, v31
  v_add_f32 v44, v44, v46
  v_add_f32 v45, v45, v47
  v_add_f32_dpp v28, v28, v28 row_ror:8 row_mask:0xf bank_mask:0xf
  v_add_f32_dpp v29, v29, v29 row_ror:8 row_mask:0xf bank_mask:0xf
  v_add_f32_dpp v44, v44, v44 row_ror:8 row_mask:0xf bank_mask:0xf
  v_add_f32_dpp v45, v45, v45 row_ror:8 row_mask:0xf bank_mask:0xf
  v_mov_b32 v30, v28
  v_mov_b32 v31, v29
  v_mov_b32 v46, v44
  v_mov_b32 v47, v45
  v_permlane16_swap_b32 v28, v30
  v_permlane16_swap_b32 v29, v31
  v_permlane16_swap_b32 v44, v46
  v_permlane16_swap_b32 v45, v47
  v_add_f32 v60, v60, v28
  v_add_f32 v61, v61, v29
  v_add_f32 v62, v62, v44
  v_add_f32 v63, v63, v45
  v_add_f32 v60, v60, v30
  v_add_f32 v61, v61, v31
  v_add_f32 v62, v62, v46
  v_add_f32 v63, v63, v47
  v_cvt_pk_bf16_f32 v28, v60, v61
  v_cvt_pk_bf16_f32 v44, v62, v63
  ds_write2_b32 v68, v28, v44 offset0:0 offset1:16
  v_lshlrev_b32 v60, 16, v28
  v_and_b32 v61, 0xffff0000, v28
  v_lshlrev_b32 v62, 16, v44
  v_and_b32 v63, 0xffff0000, v44
  s_add_u32 s16, s16, 0x10000
  s_addc_u32 s17, s17, 0
  s_waitcnt lgkmcnt(0)
  s_barrier
  ds_read_b128 v[76:79], v69 offset:0
  ds_read_b128 v[80:83], v69 offset:64
  ds_read_b128 v[84:87], v69 offset:128
  ds_read_b128 v[88:91], v69 offset:192
  v_add_f32 v29, v60, v61
  v_mul_f32 v30, v60, v60
  v_add_f32 v31, v62, v63
  v_fmac_f32 v30, v61, v61
  v_add_f32 v29, v29, v31
  v_fmac_f32 v30, v62, v62
  v_fmac_f32 v30, v63, v63
  s_waitcnt lgkmcnt(3)
  v_mfma_f32_16x16x32_bf16 v[72:75], a[128:131], v[76:79], 0
  v_permlane32_swap_b32 v29, v30
  s_waitcnt lgkmcnt(2)
  v_mfma_f32_16x16x32_bf16 v[72:75], a[132:135], v[80:83], v[72:75]
  v_add_f32 v29, v29, v30
  s_waitcnt lgkmcnt(1)
  v_mfma_f32_16x16x32_bf16 v[72:75], a[136:139], v[84:87], v[72:75]
  v_add_f32_dpp v29, v29, v29 quad_perm:[1,0,3,2] row_mask:0xf bank_mask:0xf
  s_waitcnt lgkmcnt(0)
  v_mfma_f32_16x16x32_bf16 v[72:75], a[140:143], v[88:91], v[72:75]
  v_add_f32_dpp v29, v29, v29 quad_perm:[2,3,0,1] row_mask:0xf bank_mask:0xf
  s_nop 1
  v_add_f32_dpp v29, v29, v29 row_ror:4 row_mask:0xf bank_mask:0xf
  s_bfe_u32 s96, s2, 0x30003
  s_cmp_eq_u32 s96, 0
  s_cbranch_scc0 L_nost_98
  s_mov_b32 exec_lo, 1
  s_mov_b32 exec_hi, 1
  s_cmp_eq_u32 s7, 1
  s_cbranch_scc0 L_wt_99
  buffer_store_dword v29, v10, s[16:19], s94 offen
L_back_100:
L_nost_98:
  s_mov_b32 exec_lo, 0x30003
  s_mov_b32 exec_hi, 0x30003
  v_cvt_pk_bf16_f32 v72, v72, v73
  v_cvt_pk_bf16_f32 v73, v74, v75
  s_cmp_eq_u32 s7, 1
  s_cbranch_scc0 L_wt_101
  buffer_store_dwordx2 v[72:73], v7, s[16:19], s79 offen
L_back_102:
  s_mov_b32 s6, 1
  s_cmp_eq_u32 s96, 1
  s_cbranch_scc0 L_nox_103
  s_mov_b32 exec_lo, 0xff
  s_mov_b32 exec_hi, 0xff
  s_cmp_eq_u32 s7, 1
  s_cbranch_scc0 L_wt_104
  buffer_store_dword v28, v10, s[16:19], s95 offen
  buffer_store_dword v44, v10, s[16:19], s95 offen offset:64
L_back_105:
L_nox_103:
  s_mov_b64 exec, -1
  s_branch L_layer
L_wt_4:
  buffer_store_dwordx2 v[60:61], v7, s[16:19], s79 offen sc1
  s_branch L_back_5
L_wt_6:
  buffer_store_dwordx2 v[24:25], v7, s[16:19], s95 offen sc1
  s_branch L_back_7
L_giveup_11:
  s_mov_b32 s76, 0
  s_branch L_got_10
L_giveup_16:
  s_mov_b32 s76, 0
  s_branch L_got_15
L_wt_27:
  buffer_store_dword v43, off, s[16:19], s81 sc1
  s_branch L_back_28
L_wt_29:
  buffer_store_dword v88, v2, s[16:19], s80 offen sc1
  s_branch L_back_30
L_giveup_34:
  s_mov_b32 s76, 0
  s_branch L_got_33
L_noffn_40:
  s_waitcnt vmcnt(0)
  s_branch L_ffnj_41
L_giveup_46:
  s_mov_b32 s76, 0
  s_branch L_got_45
L_giveup_51:
  s_mov_b32 s76, 0
  s_branch L_got_50
L_giveup_56:
  s_mov_b32 s76, 0
  s_branch L_got_55
L_wt_60:
  buffer_store_dword v29, v10, s[16:19], s88 offen sc1
  s_branch L_back_61
L_wt_62:
  buffer_store_dwordx4 v[40:43], v5, s[16:19], s91 offen sc1
  s_branch L_back_63
L_wt_66:
  buffer_store_dwordx2 v[46:47], v60, s[16:19], s94 offen sc1
  s_branch L_back_67
L_wt_68:
  buffer_store_dword v28, v10, s[16:19], s96 offen sc1
  s_branch L_back_69
L_giveup_75:
  s_mov_b32 s76, 0
  s_branch L_got_74
L_giveup_80:
  s_mov_b32 s76, 0
  s_branch L_dgot
L_giveup_85:
  s_mov_b32 s76, 0
  s_branch L_got_84
L_giveup_91:
  s_mov_b32 s76, 0
  s_branch L_got_90
L_giveup_96:
  s_mov_b32 s76, 0
  s_branch L_got_95
L_wt_99:
  buffer_store_dword v29, v10, s[16:19], s94 offen sc1
  s_branch L_back_100
L_wt_101:
  buffer_store_dwordx2 v[72:73], v7, s[16:19], s79 offen sc1
  s_branch L_back_102
L_wt_104:
  buffer_store_dword v28, v10, s[16:19], s95 offen sc1
  buffer_store_dword v44, v10, s[16:19], s95 offen offset:64 sc1
  s_branch L_back_105
L_fin:
L_end:
  s_endpgm
.section .rodata,"a"
.p2align 6
.amdhsa_kernel interleave_layers__gqa_block_cached__glu_gated_reglu__decode_kernel
  .amdhsa_next_free_vgpr 512
  .amdhsa_next_free_sgpr 102
  .amdhsa_accum_offset 256
  .amdhsa_group_segment_fixed_size 0
  .amdhsa_kernarg_size 96
  .amdhsa_user_sgpr_count 2
  .amdhsa_user_sgpr_kernarg_segment_ptr 1
  .amdhsa_system_sgpr_workgroup_id_x 1
.end_amdhsa_kernel
```
